```python
import torch

def _softmax(x, axis=-1):
    return torch.softmax(x, dim=axis)
def _gelu(x):
    return torch.nn.functional.gelu(x, approximate="tanh")
def _silu(x):
    return torch.nn.functional.silu(x)
def _sigmoid(x):
    return torch.sigmoid(x)
def _layernorm(x, axis=-1, eps=1e-5):
    m = x.mean(dim=axis, keepdim=True)
    v = x.var(dim=axis, keepdim=True, unbiased=False)
    return (x - m) / torch.sqrt(v + eps)
def _scatter_add(tgt, idx, src, axis=0):
    return tgt.clone().index_add_(axis, idx, src)
def _segment_sum(src, seg, n):
    out = torch.zeros((n,) + src.shape[1:], dtype=src.dtype)
    return out.index_add_(0, seg, src)
def _pad(x, pw):
    flat = tuple(v for pair in reversed(pw) for v in pair)
    return torch.nn.functional.pad(x, flat)

kernel_name = 'sequential_preLN__gqa_block_cached__mixer_channel_mlp__decode'

def setup_inputs():

    _w = (lambda a: (lambda t: t.to(torch.bfloat16) if t.is_floating_point() else t)(torch.as_tensor(a)))
    def _A_setup():
        B, Sq, D = 1, 1, 512
        Hq, Hkv, Sk, Dh = 32, 8, 65536, 128
        assert Hq % Hkv == 0, (Hq, Hkv)
        return {
            "x": _w((lambda *s: torch.randn(*s, dtype=torch.bfloat16) * 0.05)(B, Sq, D)),
            "k_cache": _w((lambda *s: torch.randn(*s, dtype=torch.bfloat16) * 3.2)(B, Hkv, Sk, Dh)),
            "v_cache": _w((lambda *s: torch.randn(*s, dtype=torch.bfloat16) * 0.4)(B, Hkv, Sk, Dh)),
            "wq": _w((lambda *s: torch.randn(*s, dtype=torch.bfloat16) * 3.2)(D, Hq * Dh) * (D ** -0.5)),
            "wo": _w((lambda *s: torch.randn(*s, dtype=torch.bfloat16) * 0.4)(Hq * Dh, D) * ((Hq * Dh) ** -0.5)),
        }
    _A_in = _A_setup()

    def _B_setup():
        B, S, D, F = 1, 1, 512, 1792
        return {
            "x": _w((lambda *s: torch.randn(*s, dtype=torch.bfloat16) * 0.05)(B, S, D)),
            "w1": _w((lambda *s: torch.randn(*s, dtype=torch.bfloat16) * 3.2)(D, F) * (D ** -0.5)),
            "b1": _w((lambda *s: torch.randn(*s, dtype=torch.bfloat16) * 3.2)(F)),
            "w2": _w((lambda *s: torch.randn(*s, dtype=torch.bfloat16) * 0.4)(F, D) * (F ** -0.5)),
            "b2": _w((lambda *s: torch.randn(*s, dtype=torch.bfloat16) * 0.8)(D)),
        }
    _B_in = _B_setup()

    return {
        "A_x": _A_in["x"],
        "A_k_cache": _A_in["k_cache"],
        "A_v_cache": _A_in["v_cache"],
        "A_wq": _A_in["wq"],
        "A_wo": _A_in["wo"],
        "B_x": _B_in["x"],
        "B_w1": _B_in["w1"],
        "B_b1": _B_in["b1"],
        "B_w2": _B_in["w2"],
        "B_b2": _B_in["b2"],
    }

def reference(A_x, A_k_cache, A_v_cache, A_wq, A_wo, B_x, B_w1, B_b1, B_w2, B_b2):
    def _A_ref(x, k_cache, v_cache, wq, wo):
        B, Sq, D = x.shape
        Hq, Dh = 32, 128
        Hkv = k_cache.shape[1]
        rep = Hq // Hkv
        q = (lambda x, *d: x.permute(*d))((x @ wq).reshape(B, Sq, Hq, Dh), 0, 2, 1, 3)
        k = (lambda x, n, axis: torch.repeat_interleave(x, n, dim=axis))(k_cache, rep, axis=1)
        v = (lambda x, n, axis: torch.repeat_interleave(x, n, dim=axis))(v_cache, rep, axis=1)
        scores = torch.einsum("bhqd,bhkd->bhqk", q, k) * (Dh ** -0.5)
        p = _softmax(scores, axis=-1)
        o = torch.einsum("bhqk,bhkd->bhqd", p, v)
        return (lambda x, *d: x.permute(*d))(o, 0, 2, 1, 3).reshape(B, Sq, Hq * Dh) @ wo

    def _B_ref(x, w1, b1, w2, b2):
        y = _layernorm(x, axis=-1)
        h = _gelu(torch.einsum("bsd,df->bsf", y, w1) + b1)
        return torch.einsum("bsf,fd->bsd", h, w2) + b2

    x = A_x
    h = x + _A_ref(_layernorm(x, axis=-1), A_k_cache, A_v_cache, A_wq, A_wo)
    h2 = h + _B_ref(_layernorm(h, axis=-1), B_w1, B_b1, B_w2, B_b2)
    return h2
```

```asm
; @launch grid=(256,1,1) block=(512,1,1) lds=86016
.amdgcn_target "amdgcn-amd-amdhsa--gfx950"
.text
.globl sequential_preLN__gqa_block_cached__mixer_channel_mlp__decode_kernel
.p2align 8
.type sequential_preLN__gqa_block_cached__mixer_channel_mlp__decode_kernel,@function
sequential_preLN__gqa_block_cached__mixer_channel_mlp__decode_kernel:
    s_cmp_ge_u32 s2, 256
    s_cbranch_scc1 L_end
    s_load_dwordx16 s[4:19], s[0:1], 0
    s_load_dwordx8 s[20:27], s[0:1], 64
    s_load_dwordx2 s[28:29], s[0:1], 96
    v_lshrrev_b32 v2, 6, v0
    v_and_b32 v1, 63, v0
    v_readfirstlane_b32 s60, v2
    s_lshr_b32 s61, s2, 5
    s_and_b32 s62, s2, 31
    s_cmp_lt_u32 s60, 4
    s_cbranch_scc1 L_service
    s_sub_u32 s60, s60, 4
    s_mul_i32 s63, s62, 33
    s_sub_u32 s63, s63, 30
    s_max_u32 s67, s62, 30
    s_sub_u32 s67, s67, 30
    s_sub_u32 s63, s63, s67
    s_mul_i32 s67, s62, 31
    s_cmp_lt_u32 s62, 15
    s_cselect_b32 s63, s67, s63
    s_cselect_b32 s64, 25, 27
    s_cmp_ge_u32 s62, 30
    s_cselect_b32 s64, 26, s64
    s_bitcmp1_b32 s62, 0
    s_cselect_b32 s67, 0, 0
    s_add_u32 s63, s63, s67
    s_bitcmp1_b32 s62, 0
    s_cselect_b32 s67, 0, 0
    s_add_u32 s64, s64, s67
    s_lshl_b32 s63, s63, 2
    s_add_u32 s63, s63, s60
    s_lshl_b32 s63, s63, 12
    s_lshl_b32 s65, s61, 24
    s_add_u32 s63, s63, s65
    v_bfe_u32 v2, v1, 2, 2
    v_lshlrev_b32 v2, 8, v2
    v_bfe_u32 v11, v1, 1, 1
    v_lshl_add_u32 v2, v11, 10, v2
    v_and_b32 v11, 1, v1
    v_lshl_add_u32 v2, v11, 6, v2
    v_lshrrev_b32 v11, 4, v1
    v_lshl_add_u32 v2, v11, 4, v2
    v_lshlrev_b32 v3, 4, v1
    s_waitcnt lgkmcnt(0)
    s_mov_b32 s32, s6
    s_and_b32 s33, s7, 0xffff
    s_mov_b32 s34, 0x8000000
    s_mov_b32 s35, 0x00020000
    s_mov_b32 s36, s8
    s_and_b32 s37, s9, 0xffff
    s_mov_b32 s38, 0x8000000
    s_mov_b32 s39, 0x00020000
    s_barrier
    buffer_load_dwordx4 v[62:65], v2, s[32:35], s63 offen offset:0 nt
    buffer_load_dwordx4 v[66:69], v2, s[32:35], s63 offen offset:128 nt
    buffer_load_dwordx4 v[70:73], v2, s[32:35], s63 offen offset:2048 nt
    buffer_load_dwordx4 v[74:77], v2, s[32:35], s63 offen offset:2176 nt
    buffer_load_dwordx4 v[78:81], v3, s[36:39], s63 offen offset:0 nt
    buffer_load_dwordx4 v[82:85], v3, s[36:39], s63 offen offset:1024 nt
    buffer_load_dwordx4 v[86:89], v3, s[36:39], s63 offen offset:2048 nt
    buffer_load_dwordx4 v[90:93], v3, s[36:39], s63 offen offset:3072 nt
    s_add_u32 s63, s63, 16384
    s_mov_b32 s40, s28
    s_and_b32 s41, s29, 0xffff
    s_mov_b32 s42, 0x20000000
    s_mov_b32 s43, 0x00020000
    v_cmp_eq_u32 vcc, 0, v1
    v_mov_b32 v254, 0x30000000
    s_nop 0
    v_cndmask_b32_e64 v254, v254, 0, vcc
    v_mov_b32 v14, 0
    v_mov_b32 v15, 0
    s_mov_b32 s68, 0x3db504f3
    s_mov_b32 s69, s68
    s_mov_b32 s70, 0x3fb8aa3b
    s_mov_b32 s71, s70
    v_mov_b32 v4, 0xff800000
    v_mov_b32 v6, 0xff800000
    v_mov_b32 v8, 0
    v_mov_b32 v9, 0
    v_mov_b32 v24, 0
    v_mov_b32 v25, 0
    v_mov_b32 v26, 0
    v_mov_b32 v27, 0
    v_mov_b32 v28, 0
    v_mov_b32 v29, 0
    v_mov_b32 v30, 0
    v_mov_b32 v31, 0
    v_mov_b32 v44, 0
    v_mov_b32 v45, 0
    v_mov_b32 v46, 0
    v_mov_b32 v47, 0
    v_mov_b32 v48, 0
    v_mov_b32 v49, 0
    v_mov_b32 v50, 0
    v_mov_b32 v51, 0
    v_mov_b32 v52, 0
    v_mov_b32 v53, 0
    v_mov_b32 v54, 0
    v_mov_b32 v55, 0
    v_mov_b32 v56, 0
    v_mov_b32 v57, 0
    v_mov_b32 v58, 0
    v_mov_b32 v59, 0
    v_mov_b32 v60, 0
    v_mov_b32 v61, 0
    v_and_b32 v11, 1, v1
    v_lshlrev_b32 v11, 4, v11
    v_mov_b32 v12, 0xffff
    v_lshlrev_b32 v12, v11, v12
    v_and_b32 v11, 2, v1
    v_cmp_eq_u32 vcc, 0, v11
    s_nop 1
    v_cndmask_b32 v5, 0, v12, vcc
    v_cndmask_b32_e64 v10, v12, 0, vcc
    v_bfe_u32 v11, v1, 2, 2
    v_lshlrev_b32 v11, 8, v11
    v_lshrrev_b32 v12, 4, v1
    v_lshl_add_u32 v11, v12, 4, v11
    v_and_b32 v12, 1, v1
    v_lshl_add_u32 v11, v12, 6, v11
    s_mov_b32 s72, 0xaaaaaaaa
    s_mov_b32 s73, 0xaaaaaaaa
    s_waitcnt vmcnt(4)
    buffer_load_dwordx4 v[94:97], v2, s[32:35], s63 offen offset:0 nt
    buffer_load_dwordx4 v[98:101], v2, s[32:35], s63 offen offset:128 nt
    buffer_load_dwordx4 v[102:105], v2, s[32:35], s63 offen offset:2048 nt
    buffer_load_dwordx4 v[106:109], v2, s[32:35], s63 offen offset:2176 nt
    s_waitcnt vmcnt(4)
    buffer_load_dwordx4 v[110:113], v3, s[36:39], s63 offen offset:0 nt
    buffer_load_dwordx4 v[114:117], v3, s[36:39], s63 offen offset:1024 nt
    buffer_load_dwordx4 v[118:121], v3, s[36:39], s63 offen offset:2048 nt
    buffer_load_dwordx4 v[122:125], v3, s[36:39], s63 offen offset:3072 nt
    s_add_u32 s63, s63, 16384
    s_waitcnt vmcnt(4)
    buffer_load_dwordx4 v[126:129], v2, s[32:35], s63 offen offset:0 nt
    buffer_load_dwordx4 v[130:133], v2, s[32:35], s63 offen offset:128 nt
    buffer_load_dwordx4 v[134:137], v2, s[32:35], s63 offen offset:2048 nt
    buffer_load_dwordx4 v[138:141], v2, s[32:35], s63 offen offset:2176 nt
    s_waitcnt vmcnt(4)
    buffer_load_dwordx4 v[142:145], v3, s[36:39], s63 offen offset:0 nt
    buffer_load_dwordx4 v[146:149], v3, s[36:39], s63 offen offset:1024 nt
    buffer_load_dwordx4 v[150:153], v3, s[36:39], s63 offen offset:2048 nt
    buffer_load_dwordx4 v[154:157], v3, s[36:39], s63 offen offset:3072 nt
    s_add_u32 s63, s63, 16384
    s_waitcnt vmcnt(4)
    buffer_load_dwordx4 v[158:161], v2, s[32:35], s63 offen offset:0 nt
    buffer_load_dwordx4 v[162:165], v2, s[32:35], s63 offen offset:128 nt
    buffer_load_dwordx4 v[166:169], v2, s[32:35], s63 offen offset:2048 nt
    buffer_load_dwordx4 v[170:173], v2, s[32:35], s63 offen offset:2176 nt
    s_waitcnt vmcnt(4)
    buffer_load_dwordx4 v[174:177], v3, s[36:39], s63 offen offset:0 nt
    buffer_load_dwordx4 v[178:181], v3, s[36:39], s63 offen offset:1024 nt
    buffer_load_dwordx4 v[182:185], v3, s[36:39], s63 offen offset:2048 nt
    buffer_load_dwordx4 v[186:189], v3, s[36:39], s63 offen offset:3072 nt
    s_add_u32 s63, s63, 16384
    s_waitcnt vmcnt(4)
    buffer_load_dwordx4 v[190:193], v2, s[32:35], s63 offen offset:0 nt
    buffer_load_dwordx4 v[194:197], v2, s[32:35], s63 offen offset:128 nt
    buffer_load_dwordx4 v[198:201], v2, s[32:35], s63 offen offset:2048 nt
    buffer_load_dwordx4 v[202:205], v2, s[32:35], s63 offen offset:2176 nt
    s_waitcnt vmcnt(4)
    buffer_load_dwordx4 v[206:209], v3, s[36:39], s63 offen offset:0 nt
    buffer_load_dwordx4 v[210:213], v3, s[36:39], s63 offen offset:1024 nt
    buffer_load_dwordx4 v[214:217], v3, s[36:39], s63 offen offset:2048 nt
    buffer_load_dwordx4 v[218:221], v3, s[36:39], s63 offen offset:3072 nt
    s_add_u32 s63, s63, 16384
    s_waitcnt vmcnt(4)
    buffer_load_dwordx4 v[222:225], v2, s[32:35], s63 offen offset:0 nt
    buffer_load_dwordx4 v[226:229], v2, s[32:35], s63 offen offset:128 nt
    buffer_load_dwordx4 v[230:233], v2, s[32:35], s63 offen offset:2048 nt
    buffer_load_dwordx4 v[234:237], v2, s[32:35], s63 offen offset:2176 nt
    s_waitcnt vmcnt(4)
    buffer_load_dwordx4 v[238:241], v3, s[36:39], s63 offen offset:0 nt
    buffer_load_dwordx4 v[242:245], v3, s[36:39], s63 offen offset:1024 nt
    buffer_load_dwordx4 v[246:249], v3, s[36:39], s63 offen offset:2048 nt
    buffer_load_dwordx4 v[250:253], v3, s[36:39], s63 offen offset:3072 nt
    s_add_u32 s63, s63, 16384
    s_barrier
    ds_read_b128 v[32:35], v11 offset:0
    ds_read_b128 v[36:39], v11 offset:128
    s_waitcnt lgkmcnt(0)
    s_waitcnt vmcnt(44)
    v_mfma_f32_16x16x32_bf16 v[16:19], v[62:65], v[32:35], 0
    v_mfma_f32_16x16x32_bf16 v[40:43], v[70:73], v[32:35], 0
    v_mfma_f32_16x16x32_bf16 v[16:19], v[66:69], v[36:39], v[16:19]
    v_mfma_f32_16x16x32_bf16 v[40:43], v[74:77], v[36:39], v[40:43]
    s_cmp_gt_i32 s64, 0
    s_cselect_b32 s76, s63, 0x30000000
    s_sub_u32 s64, s64, 1
    s_add_u32 s63, s63, 16384
    s_nop 2
    v_cndmask_b32_e64 v20, v16, v17, s[72:73]
    v_cndmask_b32_e64 v21, v18, v19, s[72:73]
    v_cndmask_b32_e64 v22, v40, v41, s[72:73]
    v_cndmask_b32_e64 v23, v42, v43, s[72:73]
    v_add_f32_dpp v20, v20, v20 quad_perm:[1,0,3,2] row_mask:0xf bank_mask:0xf
    v_add_f32_dpp v21, v21, v21 quad_perm:[1,0,3,2] row_mask:0xf bank_mask:0xf
    v_add_f32_dpp v22, v22, v22 quad_perm:[1,0,3,2] row_mask:0xf bank_mask:0xf
    v_add_f32_dpp v23, v23, v23 quad_perm:[1,0,3,2] row_mask:0xf bank_mask:0xf
    v_cvt_pk_bf16_f32 v20, 0, v20
    v_cvt_pk_bf16_f32 v21, 0, v21
    v_cvt_pk_bf16_f32 v22, 0, v22
    v_cvt_pk_bf16_f32 v23, 0, v23
    v_pk_mul_f32 v[20:21], v[20:21], s[68:69]
    v_pk_mul_f32 v[22:23], v[22:23], s[68:69]
    v_cvt_pk_bf16_f32 v20, 0, v20
    v_cvt_pk_bf16_f32 v21, 0, v21
    v_cvt_pk_bf16_f32 v22, 0, v22
    v_cvt_pk_bf16_f32 v23, 0, v23
    v_max3_f32 v11, v20, v21, v22
    v_max_f32 v11, v11, v23
    v_cmp_gt_f32 vcc, v11, v4
    s_cbranch_vccz L_nomaxp0
    v_max_f32 v4, v11, v4
    v_mov_b32 v11, v4
    s_nop 1
    v_permlane16_swap_b32 v11, v4
    v_max_f32 v4, v4, v11
    v_mov_b32 v11, v4
    s_nop 1
    v_permlane32_swap_b32 v11, v4
    v_max_f32 v4, v4, v11
    v_mul_f32 v11, s70, v4
    v_sub_f32 v12, v6, v11
    v_exp_f32 v12, v12
    v_mov_b32 v6, v11
    v_pk_mul_f32 v[24:25], v[24:25], v[12:13] op_sel_hi:[1,0]
    v_pk_mul_f32 v[26:27], v[26:27], v[12:13] op_sel_hi:[1,0]
    v_pk_mul_f32 v[28:29], v[28:29], v[12:13] op_sel_hi:[1,0]
    v_pk_mul_f32 v[30:31], v[30:31], v[12:13] op_sel_hi:[1,0]
    v_pk_mul_f32 v[8:9], v[8:9], v[12:13] op_sel_hi:[1,0]
L_nomaxp0:
    v_pk_fma_f32 v[20:21], v[20:21], s[70:71], v[6:7] op_sel_hi:[1,1,0] neg_lo:[0,0,1] neg_hi:[0,0,1]
    v_pk_fma_f32 v[22:23], v[22:23], s[70:71], v[6:7] op_sel_hi:[1,1,0] neg_lo:[0,0,1] neg_hi:[0,0,1]
    v_exp_f32 v20, v20
    v_exp_f32 v21, v21
    v_exp_f32 v22, v22
    v_exp_f32 v23, v23
    v_cvt_pk_bf16_f32 v16, v20, v20
    v_cvt_pk_bf16_f32 v17, v21, v21
    v_cvt_pk_bf16_f32 v18, v22, v22
    v_cvt_pk_bf16_f32 v19, v23, v23
    v_and_b32 v46, v16, v5
    v_and_b32 v47, v16, v10
    v_and_b32 v50, v17, v5
    v_and_b32 v51, v17, v10
    v_and_b32 v54, v18, v5
    v_and_b32 v55, v18, v10
    v_and_b32 v58, v19, v5
    v_and_b32 v59, v19, v10
    v_pk_add_f32 v[8:9], v[8:9], v[20:21]
    v_pk_add_f32 v[8:9], v[8:9], v[22:23]
    s_waitcnt vmcnt(40)
    v_mfma_f32_16x16x32_bf16 v[24:27], v[78:81], v[46:49], v[24:27]
    v_mfma_f32_16x16x32_bf16 v[28:31], v[78:81], v[44:47], v[28:31]
    v_mfma_f32_16x16x32_bf16 v[24:27], v[82:85], v[50:53], v[24:27]
    v_mfma_f32_16x16x32_bf16 v[28:31], v[82:85], v[48:51], v[28:31]
    v_mfma_f32_16x16x32_bf16 v[24:27], v[86:89], v[54:57], v[24:27]
    v_mfma_f32_16x16x32_bf16 v[28:31], v[86:89], v[52:55], v[28:31]
    v_mfma_f32_16x16x32_bf16 v[24:27], v[90:93], v[58:61], v[24:27]
    v_mfma_f32_16x16x32_bf16 v[28:31], v[90:93], v[56:59], v[28:31]
    buffer_load_dwordx4 v[62:65], v2, s[32:35], s76 offen offset:0 nt
    buffer_load_dwordx4 v[66:69], v2, s[32:35], s76 offen offset:128 nt
    buffer_load_dwordx4 v[70:73], v2, s[32:35], s76 offen offset:2048 nt
    buffer_load_dwordx4 v[74:77], v2, s[32:35], s76 offen offset:2176 nt
    buffer_load_dwordx4 v[78:81], v3, s[36:39], s76 offen offset:0 nt
    buffer_load_dwordx4 v[82:85], v3, s[36:39], s76 offen offset:1024 nt
    buffer_load_dwordx4 v[86:89], v3, s[36:39], s76 offen offset:2048 nt
    buffer_load_dwordx4 v[90:93], v3, s[36:39], s76 offen offset:3072 nt
    s_waitcnt vmcnt(44)
    v_mfma_f32_16x16x32_bf16 v[16:19], v[94:97], v[32:35], 0
    v_mfma_f32_16x16x32_bf16 v[40:43], v[102:105], v[32:35], 0
    v_mfma_f32_16x16x32_bf16 v[16:19], v[98:101], v[36:39], v[16:19]
    v_mfma_f32_16x16x32_bf16 v[40:43], v[106:109], v[36:39], v[40:43]
    s_cmp_gt_i32 s64, 0
    s_cselect_b32 s77, s63, 0x30000000
    s_sub_u32 s64, s64, 1
    s_add_u32 s63, s63, 16384
    s_nop 2
    v_cndmask_b32_e64 v20, v16, v17, s[72:73]
    v_cndmask_b32_e64 v21, v18, v19, s[72:73]
    v_cndmask_b32_e64 v22, v40, v41, s[72:73]
    v_cndmask_b32_e64 v23, v42, v43, s[72:73]
    v_add_f32_dpp v20, v20, v20 quad_perm:[1,0,3,2] row_mask:0xf bank_mask:0xf
    v_add_f32_dpp v21, v21, v21 quad_perm:[1,0,3,2] row_mask:0xf bank_mask:0xf
    v_add_f32_dpp v22, v22, v22 quad_perm:[1,0,3,2] row_mask:0xf bank_mask:0xf
    v_add_f32_dpp v23, v23, v23 quad_perm:[1,0,3,2] row_mask:0xf bank_mask:0xf
    v_cvt_pk_bf16_f32 v20, 0, v20
    v_cvt_pk_bf16_f32 v21, 0, v21
    v_cvt_pk_bf16_f32 v22, 0, v22
    v_cvt_pk_bf16_f32 v23, 0, v23
    v_pk_mul_f32 v[20:21], v[20:21], s[68:69]
    v_pk_mul_f32 v[22:23], v[22:23], s[68:69]
    v_cvt_pk_bf16_f32 v20, 0, v20
    v_cvt_pk_bf16_f32 v21, 0, v21
    v_cvt_pk_bf16_f32 v22, 0, v22
    v_cvt_pk_bf16_f32 v23, 0, v23
    v_max3_f32 v11, v20, v21, v22
    v_max_f32 v11, v11, v23
    v_cmp_gt_f32 vcc, v11, v4
    s_cbranch_vccz L_nomaxp1
    v_max_f32 v4, v11, v4
    v_mov_b32 v11, v4
    s_nop 1
    v_permlane16_swap_b32 v11, v4
    v_max_f32 v4, v4, v11
    v_mov_b32 v11, v4
    s_nop 1
    v_permlane32_swap_b32 v11, v4
    v_max_f32 v4, v4, v11
    v_mul_f32 v11, s70, v4
    v_sub_f32 v12, v6, v11
    v_exp_f32 v12, v12
    v_mov_b32 v6, v11
    v_pk_mul_f32 v[24:25], v[24:25], v[12:13] op_sel_hi:[1,0]
    v_pk_mul_f32 v[26:27], v[26:27], v[12:13] op_sel_hi:[1,0]
    v_pk_mul_f32 v[28:29], v[28:29], v[12:13] op_sel_hi:[1,0]
    v_pk_mul_f32 v[30:31], v[30:31], v[12:13] op_sel_hi:[1,0]
    v_pk_mul_f32 v[8:9], v[8:9], v[12:13] op_sel_hi:[1,0]
L_nomaxp1:
    v_pk_fma_f32 v[20:21], v[20:21], s[70:71], v[6:7] op_sel_hi:[1,1,0] neg_lo:[0,0,1] neg_hi:[0,0,1]
    v_pk_fma_f32 v[22:23], v[22:23], s[70:71], v[6:7] op_sel_hi:[1,1,0] neg_lo:[0,0,1] neg_hi:[0,0,1]
    v_exp_f32 v20, v20
    v_exp_f32 v21, v21
    v_exp_f32 v22, v22
    v_exp_f32 v23, v23
    v_cvt_pk_bf16_f32 v16, v20, v20
    v_cvt_pk_bf16_f32 v17, v21, v21
    v_cvt_pk_bf16_f32 v18, v22, v22
    v_cvt_pk_bf16_f32 v19, v23, v23
    v_and_b32 v46, v16, v5
    v_and_b32 v47, v16, v10
    v_and_b32 v50, v17, v5
    v_and_b32 v51, v17, v10
    v_and_b32 v54, v18, v5
    v_and_b32 v55, v18, v10
    v_and_b32 v58, v19, v5
    v_and_b32 v59, v19, v10
    v_pk_add_f32 v[8:9], v[8:9], v[20:21]
    v_pk_add_f32 v[8:9], v[8:9], v[22:23]
    s_waitcnt vmcnt(40)
    v_mfma_f32_16x16x32_bf16 v[24:27], v[110:113], v[46:49], v[24:27]
    v_mfma_f32_16x16x32_bf16 v[28:31], v[110:113], v[44:47], v[28:31]
    v_mfma_f32_16x16x32_bf16 v[24:27], v[114:117], v[50:53], v[24:27]
    v_mfma_f32_16x16x32_bf16 v[28:31], v[114:117], v[48:51], v[28:31]
    v_mfma_f32_16x16x32_bf16 v[24:27], v[118:121], v[54:57], v[24:27]
    v_mfma_f32_16x16x32_bf16 v[28:31], v[118:121], v[52:55], v[28:31]
    v_mfma_f32_16x16x32_bf16 v[24:27], v[122:125], v[58:61], v[24:27]
    v_mfma_f32_16x16x32_bf16 v[28:31], v[122:125], v[56:59], v[28:31]
    buffer_load_dwordx4 v[94:97], v2, s[32:35], s77 offen offset:0 nt
    buffer_load_dwordx4 v[98:101], v2, s[32:35], s77 offen offset:128 nt
    buffer_load_dwordx4 v[102:105], v2, s[32:35], s77 offen offset:2048 nt
    buffer_load_dwordx4 v[106:109], v2, s[32:35], s77 offen offset:2176 nt
    buffer_load_dwordx4 v[110:113], v3, s[36:39], s77 offen offset:0 nt
    buffer_load_dwordx4 v[114:117], v3, s[36:39], s77 offen offset:1024 nt
    buffer_load_dwordx4 v[118:121], v3, s[36:39], s77 offen offset:2048 nt
    buffer_load_dwordx4 v[122:125], v3, s[36:39], s77 offen offset:3072 nt
    s_waitcnt vmcnt(44)
    v_mfma_f32_16x16x32_bf16 v[16:19], v[126:129], v[32:35], 0
    v_mfma_f32_16x16x32_bf16 v[40:43], v[134:137], v[32:35], 0
    v_mfma_f32_16x16x32_bf16 v[16:19], v[130:133], v[36:39], v[16:19]
    v_mfma_f32_16x16x32_bf16 v[40:43], v[138:141], v[36:39], v[40:43]
    s_nop 6
    v_cndmask_b32_e64 v20, v16, v17, s[72:73]
    v_cndmask_b32_e64 v21, v18, v19, s[72:73]
    v_cndmask_b32_e64 v22, v40, v41, s[72:73]
    v_cndmask_b32_e64 v23, v42, v43, s[72:73]
    v_add_f32_dpp v20, v20, v20 quad_perm:[1,0,3,2] row_mask:0xf bank_mask:0xf
    v_add_f32_dpp v21, v21, v21 quad_perm:[1,0,3,2] row_mask:0xf bank_mask:0xf
    v_add_f32_dpp v22, v22, v22 quad_perm:[1,0,3,2] row_mask:0xf bank_mask:0xf
    v_add_f32_dpp v23, v23, v23 quad_perm:[1,0,3,2] row_mask:0xf bank_mask:0xf
    v_cvt_pk_bf16_f32 v20, 0, v20
    v_cvt_pk_bf16_f32 v21, 0, v21
    v_cvt_pk_bf16_f32 v22, 0, v22
    v_cvt_pk_bf16_f32 v23, 0, v23
    v_pk_mul_f32 v[20:21], v[20:21], s[68:69]
    v_pk_mul_f32 v[22:23], v[22:23], s[68:69]
    v_cvt_pk_bf16_f32 v20, 0, v20
    v_cvt_pk_bf16_f32 v21, 0, v21
    v_cvt_pk_bf16_f32 v22, 0, v22
    v_cvt_pk_bf16_f32 v23, 0, v23
    v_max3_f32 v11, v20, v21, v22
    v_max_f32 v11, v11, v23
    v_cmp_gt_f32 vcc, v11, v4
    s_cbranch_vccz L_nomaxp2
    v_max_f32 v4, v11, v4
    v_mov_b32 v11, v4
    s_nop 1
    v_permlane16_swap_b32 v11, v4
    v_max_f32 v4, v4, v11
    v_mov_b32 v11, v4
    s_nop 1
    v_permlane32_swap_b32 v11, v4
    v_max_f32 v4, v4, v11
    v_mul_f32 v11, s70, v4
    v_sub_f32 v12, v6, v11
    v_exp_f32 v12, v12
    v_mov_b32 v6, v11
    v_pk_mul_f32 v[24:25], v[24:25], v[12:13] op_sel_hi:[1,0]
    v_pk_mul_f32 v[26:27], v[26:27], v[12:13] op_sel_hi:[1,0]
    v_pk_mul_f32 v[28:29], v[28:29], v[12:13] op_sel_hi:[1,0]
    v_pk_mul_f32 v[30:31], v[30:31], v[12:13] op_sel_hi:[1,0]
    v_pk_mul_f32 v[8:9], v[8:9], v[12:13] op_sel_hi:[1,0]
L_nomaxp2:
    v_pk_fma_f32 v[20:21], v[20:21], s[70:71], v[6:7] op_sel_hi:[1,1,0] neg_lo:[0,0,1] neg_hi:[0,0,1]
    v_pk_fma_f32 v[22:23], v[22:23], s[70:71], v[6:7] op_sel_hi:[1,1,0] neg_lo:[0,0,1] neg_hi:[0,0,1]
    v_exp_f32 v20, v20
    v_exp_f32 v21, v21
    v_exp_f32 v22, v22
    v_exp_f32 v23, v23
    v_cvt_pk_bf16_f32 v16, v20, v20
    v_cvt_pk_bf16_f32 v17, v21, v21
    v_cvt_pk_bf16_f32 v18, v22, v22
    v_cvt_pk_bf16_f32 v19, v23, v23
    v_and_b32 v46, v16, v5
    v_and_b32 v47, v16, v10
    v_and_b32 v50, v17, v5
    v_and_b32 v51, v17, v10
    v_and_b32 v54, v18, v5
    v_and_b32 v55, v18, v10
    v_and_b32 v58, v19, v5
    v_and_b32 v59, v19, v10
    v_pk_add_f32 v[8:9], v[8:9], v[20:21]
    v_pk_add_f32 v[8:9], v[8:9], v[22:23]
    s_waitcnt vmcnt(40)
    v_mfma_f32_16x16x32_bf16 v[24:27], v[142:145], v[46:49], v[24:27]
    v_mfma_f32_16x16x32_bf16 v[28:31], v[142:145], v[44:47], v[28:31]
    v_mfma_f32_16x16x32_bf16 v[24:27], v[146:149], v[50:53], v[24:27]
    v_mfma_f32_16x16x32_bf16 v[28:31], v[146:149], v[48:51], v[28:31]
    v_mfma_f32_16x16x32_bf16 v[24:27], v[150:153], v[54:57], v[24:27]
    v_mfma_f32_16x16x32_bf16 v[28:31], v[150:153], v[52:55], v[28:31]
    v_mfma_f32_16x16x32_bf16 v[24:27], v[154:157], v[58:61], v[24:27]
    v_mfma_f32_16x16x32_bf16 v[28:31], v[154:157], v[56:59], v[28:31]
    s_waitcnt vmcnt(36)
    v_mfma_f32_16x16x32_bf16 v[16:19], v[158:161], v[32:35], 0
    v_mfma_f32_16x16x32_bf16 v[40:43], v[166:169], v[32:35], 0
    v_mfma_f32_16x16x32_bf16 v[16:19], v[162:165], v[36:39], v[16:19]
    v_mfma_f32_16x16x32_bf16 v[40:43], v[170:173], v[36:39], v[40:43]
    s_nop 6
    v_cndmask_b32_e64 v20, v16, v17, s[72:73]
    v_cndmask_b32_e64 v21, v18, v19, s[72:73]
    v_cndmask_b32_e64 v22, v40, v41, s[72:73]
    v_cndmask_b32_e64 v23, v42, v43, s[72:73]
    v_add_f32_dpp v20, v20, v20 quad_perm:[1,0,3,2] row_mask:0xf bank_mask:0xf
    v_add_f32_dpp v21, v21, v21 quad_perm:[1,0,3,2] row_mask:0xf bank_mask:0xf
    v_add_f32_dpp v22, v22, v22 quad_perm:[1,0,3,2] row_mask:0xf bank_mask:0xf
    v_add_f32_dpp v23, v23, v23 quad_perm:[1,0,3,2] row_mask:0xf bank_mask:0xf
    v_cvt_pk_bf16_f32 v20, 0, v20
    v_cvt_pk_bf16_f32 v21, 0, v21
    v_cvt_pk_bf16_f32 v22, 0, v22
    v_cvt_pk_bf16_f32 v23, 0, v23
    v_pk_mul_f32 v[20:21], v[20:21], s[68:69]
    v_pk_mul_f32 v[22:23], v[22:23], s[68:69]
    v_cvt_pk_bf16_f32 v20, 0, v20
    v_cvt_pk_bf16_f32 v21, 0, v21
    v_cvt_pk_bf16_f32 v22, 0, v22
    v_cvt_pk_bf16_f32 v23, 0, v23
    v_max3_f32 v11, v20, v21, v22
    v_max_f32 v11, v11, v23
    v_cmp_gt_f32 vcc, v11, v4
    s_cbranch_vccz L_nomaxp3
    v_max_f32 v4, v11, v4
    v_mov_b32 v11, v4
    s_nop 1
    v_permlane16_swap_b32 v11, v4
    v_max_f32 v4, v4, v11
    v_mov_b32 v11, v4
    s_nop 1
    v_permlane32_swap_b32 v11, v4
    v_max_f32 v4, v4, v11
    v_mul_f32 v11, s70, v4
    v_sub_f32 v12, v6, v11
    v_exp_f32 v12, v12
    v_mov_b32 v6, v11
    v_pk_mul_f32 v[24:25], v[24:25], v[12:13] op_sel_hi:[1,0]
    v_pk_mul_f32 v[26:27], v[26:27], v[12:13] op_sel_hi:[1,0]
    v_pk_mul_f32 v[28:29], v[28:29], v[12:13] op_sel_hi:[1,0]
    v_pk_mul_f32 v[30:31], v[30:31], v[12:13] op_sel_hi:[1,0]
    v_pk_mul_f32 v[8:9], v[8:9], v[12:13] op_sel_hi:[1,0]
L_nomaxp3:
    v_pk_fma_f32 v[20:21], v[20:21], s[70:71], v[6:7] op_sel_hi:[1,1,0] neg_lo:[0,0,1] neg_hi:[0,0,1]
    v_pk_fma_f32 v[22:23], v[22:23], s[70:71], v[6:7] op_sel_hi:[1,1,0] neg_lo:[0,0,1] neg_hi:[0,0,1]
    v_exp_f32 v20, v20
    v_exp_f32 v21, v21
    v_exp_f32 v22, v22
    v_exp_f32 v23, v23
    v_cvt_pk_bf16_f32 v16, v20, v20
    v_cvt_pk_bf16_f32 v17, v21, v21
    v_cvt_pk_bf16_f32 v18, v22, v22
    v_cvt_pk_bf16_f32 v19, v23, v23
    v_and_b32 v46, v16, v5
    v_and_b32 v47, v16, v10
    v_and_b32 v50, v17, v5
    v_and_b32 v51, v17, v10
    v_and_b32 v54, v18, v5
    v_and_b32 v55, v18, v10
    v_and_b32 v58, v19, v5
    v_and_b32 v59, v19, v10
    v_pk_add_f32 v[8:9], v[8:9], v[20:21]
    v_pk_add_f32 v[8:9], v[8:9], v[22:23]
    s_waitcnt vmcnt(32)
    v_mfma_f32_16x16x32_bf16 v[24:27], v[174:177], v[46:49], v[24:27]
    v_mfma_f32_16x16x32_bf16 v[28:31], v[174:177], v[44:47], v[28:31]
    v_mfma_f32_16x16x32_bf16 v[24:27], v[178:181], v[50:53], v[24:27]
    v_mfma_f32_16x16x32_bf16 v[28:31], v[178:181], v[48:51], v[28:31]
    v_mfma_f32_16x16x32_bf16 v[24:27], v[182:185], v[54:57], v[24:27]
    v_mfma_f32_16x16x32_bf16 v[28:31], v[182:185], v[52:55], v[28:31]
    v_mfma_f32_16x16x32_bf16 v[24:27], v[186:189], v[58:61], v[24:27]
    v_mfma_f32_16x16x32_bf16 v[28:31], v[186:189], v[56:59], v[28:31]
    s_waitcnt vmcnt(28)
    v_mfma_f32_16x16x32_bf16 v[16:19], v[190:193], v[32:35], 0
    v_mfma_f32_16x16x32_bf16 v[40:43], v[198:201], v[32:35], 0
    v_mfma_f32_16x16x32_bf16 v[16:19], v[194:197], v[36:39], v[16:19]
    v_mfma_f32_16x16x32_bf16 v[40:43], v[202:205], v[36:39], v[40:43]
    s_nop 6
    v_cndmask_b32_e64 v20, v16, v17, s[72:73]
    v_cndmask_b32_e64 v21, v18, v19, s[72:73]
    v_cndmask_b32_e64 v22, v40, v41, s[72:73]
    v_cndmask_b32_e64 v23, v42, v43, s[72:73]
    v_add_f32_dpp v20, v20, v20 quad_perm:[1,0,3,2] row_mask:0xf bank_mask:0xf
    v_add_f32_dpp v21, v21, v21 quad_perm:[1,0,3,2] row_mask:0xf bank_mask:0xf
    v_add_f32_dpp v22, v22, v22 quad_perm:[1,0,3,2] row_mask:0xf bank_mask:0xf
    v_add_f32_dpp v23, v23, v23 quad_perm:[1,0,3,2] row_mask:0xf bank_mask:0xf
    v_cvt_pk_bf16_f32 v20, 0, v20
    v_cvt_pk_bf16_f32 v21, 0, v21
    v_cvt_pk_bf16_f32 v22, 0, v22
    v_cvt_pk_bf16_f32 v23, 0, v23
    v_pk_mul_f32 v[20:21], v[20:21], s[68:69]
    v_pk_mul_f32 v[22:23], v[22:23], s[68:69]
    v_cvt_pk_bf16_f32 v20, 0, v20
    v_cvt_pk_bf16_f32 v21, 0, v21
    v_cvt_pk_bf16_f32 v22, 0, v22
    v_cvt_pk_bf16_f32 v23, 0, v23
    v_max3_f32 v11, v20, v21, v22
    v_max_f32 v11, v11, v23
    v_cmp_gt_f32 vcc, v11, v4
    s_cbranch_vccz L_nomaxp4
    v_max_f32 v4, v11, v4
    v_mov_b32 v11, v4
    s_nop 1
    v_permlane16_swap_b32 v11, v4
    v_max_f32 v4, v4, v11
    v_mov_b32 v11, v4
    s_nop 1
    v_permlane32_swap_b32 v11, v4
    v_max_f32 v4, v4, v11
    v_mul_f32 v11, s70, v4
    v_sub_f32 v12, v6, v11
    v_exp_f32 v12, v12
    v_mov_b32 v6, v11
    v_pk_mul_f32 v[24:25], v[24:25], v[12:13] op_sel_hi:[1,0]
    v_pk_mul_f32 v[26:27], v[26:27], v[12:13] op_sel_hi:[1,0]
    v_pk_mul_f32 v[28:29], v[28:29], v[12:13] op_sel_hi:[1,0]
    v_pk_mul_f32 v[30:31], v[30:31], v[12:13] op_sel_hi:[1,0]
    v_pk_mul_f32 v[8:9], v[8:9], v[12:13] op_sel_hi:[1,0]
L_nomaxp4:
    v_pk_fma_f32 v[20:21], v[20:21], s[70:71], v[6:7] op_sel_hi:[1,1,0] neg_lo:[0,0,1] neg_hi:[0,0,1]
    v_pk_fma_f32 v[22:23], v[22:23], s[70:71], v[6:7] op_sel_hi:[1,1,0] neg_lo:[0,0,1] neg_hi:[0,0,1]
    v_exp_f32 v20, v20
    v_exp_f32 v21, v21
    v_exp_f32 v22, v22
    v_exp_f32 v23, v23
    v_cvt_pk_bf16_f32 v16, v20, v20
    v_cvt_pk_bf16_f32 v17, v21, v21
    v_cvt_pk_bf16_f32 v18, v22, v22
    v_cvt_pk_bf16_f32 v19, v23, v23
    v_and_b32 v46, v16, v5
    v_and_b32 v47, v16, v10
    v_and_b32 v50, v17, v5
    v_and_b32 v51, v17, v10
    v_and_b32 v54, v18, v5
    v_and_b32 v55, v18, v10
    v_and_b32 v58, v19, v5
    v_and_b32 v59, v19, v10
    v_pk_add_f32 v[8:9], v[8:9], v[20:21]
    v_pk_add_f32 v[8:9], v[8:9], v[22:23]
    s_waitcnt vmcnt(24)
    v_mfma_f32_16x16x32_bf16 v[24:27], v[206:209], v[46:49], v[24:27]
    v_mfma_f32_16x16x32_bf16 v[28:31], v[206:209], v[44:47], v[28:31]
    v_mfma_f32_16x16x32_bf16 v[24:27], v[210:213], v[50:53], v[24:27]
    v_mfma_f32_16x16x32_bf16 v[28:31], v[210:213], v[48:51], v[28:31]
    v_mfma_f32_16x16x32_bf16 v[24:27], v[214:217], v[54:57], v[24:27]
    v_mfma_f32_16x16x32_bf16 v[28:31], v[214:217], v[52:55], v[28:31]
    v_mfma_f32_16x16x32_bf16 v[24:27], v[218:221], v[58:61], v[24:27]
    v_mfma_f32_16x16x32_bf16 v[28:31], v[218:221], v[56:59], v[28:31]
    s_waitcnt vmcnt(20)
    v_mfma_f32_16x16x32_bf16 v[16:19], v[222:225], v[32:35], 0
    v_mfma_f32_16x16x32_bf16 v[40:43], v[230:233], v[32:35], 0
    v_mfma_f32_16x16x32_bf16 v[16:19], v[226:229], v[36:39], v[16:19]
    v_mfma_f32_16x16x32_bf16 v[40:43], v[234:237], v[36:39], v[40:43]
    s_nop 6
    v_cndmask_b32_e64 v20, v16, v17, s[72:73]
    v_cndmask_b32_e64 v21, v18, v19, s[72:73]
    v_cndmask_b32_e64 v22, v40, v41, s[72:73]
    v_cndmask_b32_e64 v23, v42, v43, s[72:73]
    v_add_f32_dpp v20, v20, v20 quad_perm:[1,0,3,2] row_mask:0xf bank_mask:0xf
    v_add_f32_dpp v21, v21, v21 quad_perm:[1,0,3,2] row_mask:0xf bank_mask:0xf
    v_add_f32_dpp v22, v22, v22 quad_perm:[1,0,3,2] row_mask:0xf bank_mask:0xf
    v_add_f32_dpp v23, v23, v23 quad_perm:[1,0,3,2] row_mask:0xf bank_mask:0xf
    v_cvt_pk_bf16_f32 v20, 0, v20
    v_cvt_pk_bf16_f32 v21, 0, v21
    v_cvt_pk_bf16_f32 v22, 0, v22
    v_cvt_pk_bf16_f32 v23, 0, v23
    v_pk_mul_f32 v[20:21], v[20:21], s[68:69]
    v_pk_mul_f32 v[22:23], v[22:23], s[68:69]
    v_cvt_pk_bf16_f32 v20, 0, v20
    v_cvt_pk_bf16_f32 v21, 0, v21
    v_cvt_pk_bf16_f32 v22, 0, v22
    v_cvt_pk_bf16_f32 v23, 0, v23
    v_max3_f32 v11, v20, v21, v22
    v_max_f32 v11, v11, v23
    v_cmp_gt_f32 vcc, v11, v4
    s_cbranch_vccz L_nomaxp5
    v_max_f32 v4, v11, v4
    v_mov_b32 v11, v4
    s_nop 1
    v_permlane16_swap_b32 v11, v4
    v_max_f32 v4, v4, v11
    v_mov_b32 v11, v4
    s_nop 1
    v_permlane32_swap_b32 v11, v4
    v_max_f32 v4, v4, v11
    v_mul_f32 v11, s70, v4
    v_sub_f32 v12, v6, v11
    v_exp_f32 v12, v12
    v_mov_b32 v6, v11
    v_pk_mul_f32 v[24:25], v[24:25], v[12:13] op_sel_hi:[1,0]
    v_pk_mul_f32 v[26:27], v[26:27], v[12:13] op_sel_hi:[1,0]
    v_pk_mul_f32 v[28:29], v[28:29], v[12:13] op_sel_hi:[1,0]
    v_pk_mul_f32 v[30:31], v[30:31], v[12:13] op_sel_hi:[1,0]
    v_pk_mul_f32 v[8:9], v[8:9], v[12:13] op_sel_hi:[1,0]
L_nomaxp5:
    v_pk_fma_f32 v[20:21], v[20:21], s[70:71], v[6:7] op_sel_hi:[1,1,0] neg_lo:[0,0,1] neg_hi:[0,0,1]
    v_pk_fma_f32 v[22:23], v[22:23], s[70:71], v[6:7] op_sel_hi:[1,1,0] neg_lo:[0,0,1] neg_hi:[0,0,1]
    v_exp_f32 v20, v20
    v_exp_f32 v21, v21
    v_exp_f32 v22, v22
    v_exp_f32 v23, v23
    v_cvt_pk_bf16_f32 v16, v20, v20
    v_cvt_pk_bf16_f32 v17, v21, v21
    v_cvt_pk_bf16_f32 v18, v22, v22
    v_cvt_pk_bf16_f32 v19, v23, v23
    v_and_b32 v46, v16, v5
    v_and_b32 v47, v16, v10
    v_and_b32 v50, v17, v5
    v_and_b32 v51, v17, v10
    v_and_b32 v54, v18, v5
    v_and_b32 v55, v18, v10
    v_and_b32 v58, v19, v5
    v_and_b32 v59, v19, v10
    v_pk_add_f32 v[8:9], v[8:9], v[20:21]
    v_pk_add_f32 v[8:9], v[8:9], v[22:23]
    s_waitcnt vmcnt(16)
    v_mfma_f32_16x16x32_bf16 v[24:27], v[238:241], v[46:49], v[24:27]
    v_mfma_f32_16x16x32_bf16 v[28:31], v[238:241], v[44:47], v[28:31]
    v_mfma_f32_16x16x32_bf16 v[24:27], v[242:245], v[50:53], v[24:27]
    v_mfma_f32_16x16x32_bf16 v[28:31], v[242:245], v[48:51], v[28:31]
    v_mfma_f32_16x16x32_bf16 v[24:27], v[246:249], v[54:57], v[24:27]
    v_mfma_f32_16x16x32_bf16 v[28:31], v[246:249], v[52:55], v[28:31]
    v_mfma_f32_16x16x32_bf16 v[24:27], v[250:253], v[58:61], v[24:27]
    v_mfma_f32_16x16x32_bf16 v[28:31], v[250:253], v[56:59], v[28:31]
L_loop:
    s_waitcnt vmcnt(12)
    v_mfma_f32_16x16x32_bf16 v[16:19], v[62:65], v[32:35], 0
    v_mfma_f32_16x16x32_bf16 v[40:43], v[70:73], v[32:35], 0
    v_mfma_f32_16x16x32_bf16 v[16:19], v[66:69], v[36:39], v[16:19]
    v_mfma_f32_16x16x32_bf16 v[40:43], v[74:77], v[36:39], v[40:43]
    s_cmp_gt_i32 s64, 0
    s_cselect_b32 s76, s63, 0x30000000
    s_sub_u32 s64, s64, 1
    s_add_u32 s63, s63, 16384
    s_nop 2
    v_cndmask_b32_e64 v20, v16, v17, s[72:73]
    v_cndmask_b32_e64 v21, v18, v19, s[72:73]
    v_cndmask_b32_e64 v22, v40, v41, s[72:73]
    v_cndmask_b32_e64 v23, v42, v43, s[72:73]
    v_add_f32_dpp v20, v20, v20 quad_perm:[1,0,3,2] row_mask:0xf bank_mask:0xf
    v_add_f32_dpp v21, v21, v21 quad_perm:[1,0,3,2] row_mask:0xf bank_mask:0xf
    v_add_f32_dpp v22, v22, v22 quad_perm:[1,0,3,2] row_mask:0xf bank_mask:0xf
    v_add_f32_dpp v23, v23, v23 quad_perm:[1,0,3,2] row_mask:0xf bank_mask:0xf
    v_cvt_pk_bf16_f32 v20, 0, v20
    v_cvt_pk_bf16_f32 v21, 0, v21
    v_cvt_pk_bf16_f32 v22, 0, v22
    v_cvt_pk_bf16_f32 v23, 0, v23
    v_pk_mul_f32 v[20:21], v[20:21], s[68:69]
    v_pk_mul_f32 v[22:23], v[22:23], s[68:69]
    v_cvt_pk_bf16_f32 v20, 0, v20
    v_cvt_pk_bf16_f32 v21, 0, v21
    v_cvt_pk_bf16_f32 v22, 0, v22
    v_cvt_pk_bf16_f32 v23, 0, v23
    v_max3_f32 v11, v20, v21, v22
    v_max_f32 v11, v11, v23
    v_cmp_gt_f32 vcc, v11, v4
    s_cbranch_vccz L_nomaxa
    v_max_f32 v4, v11, v4
    v_mov_b32 v11, v4
    s_nop 1
    v_permlane16_swap_b32 v11, v4
    v_max_f32 v4, v4, v11
    v_mov_b32 v11, v4
    s_nop 1
    v_permlane32_swap_b32 v11, v4
    v_max_f32 v4, v4, v11
    v_mul_f32 v11, s70, v4
    v_sub_f32 v12, v6, v11
    v_exp_f32 v12, v12
    v_mov_b32 v6, v11
    v_pk_mul_f32 v[24:25], v[24:25], v[12:13] op_sel_hi:[1,0]
    v_pk_mul_f32 v[26:27], v[26:27], v[12:13] op_sel_hi:[1,0]
    v_pk_mul_f32 v[28:29], v[28:29], v[12:13] op_sel_hi:[1,0]
    v_pk_mul_f32 v[30:31], v[30:31], v[12:13] op_sel_hi:[1,0]
    v_pk_mul_f32 v[8:9], v[8:9], v[12:13] op_sel_hi:[1,0]
L_nomaxa:
    v_pk_fma_f32 v[20:21], v[20:21], s[70:71], v[6:7] op_sel_hi:[1,1,0] neg_lo:[0,0,1] neg_hi:[0,0,1]
    v_pk_fma_f32 v[22:23], v[22:23], s[70:71], v[6:7] op_sel_hi:[1,1,0] neg_lo:[0,0,1] neg_hi:[0,0,1]
    v_exp_f32 v20, v20
    v_exp_f32 v21, v21
    v_exp_f32 v22, v22
    v_exp_f32 v23, v23
    v_cvt_pk_bf16_f32 v16, v20, v20
    v_cvt_pk_bf16_f32 v17, v21, v21
    v_cvt_pk_bf16_f32 v18, v22, v22
    v_cvt_pk_bf16_f32 v19, v23, v23
    v_and_b32 v46, v16, v5
    v_and_b32 v47, v16, v10
    v_and_b32 v50, v17, v5
    v_and_b32 v51, v17, v10
    v_and_b32 v54, v18, v5
    v_and_b32 v55, v18, v10
    v_and_b32 v58, v19, v5
    v_and_b32 v59, v19, v10
    v_pk_add_f32 v[8:9], v[8:9], v[20:21]
    v_pk_add_f32 v[8:9], v[8:9], v[22:23]
    s_waitcnt vmcnt(8)
    v_mfma_f32_16x16x32_bf16 v[24:27], v[78:81], v[46:49], v[24:27]
    v_mfma_f32_16x16x32_bf16 v[28:31], v[78:81], v[44:47], v[28:31]
    v_mfma_f32_16x16x32_bf16 v[24:27], v[82:85], v[50:53], v[24:27]
    v_mfma_f32_16x16x32_bf16 v[28:31], v[82:85], v[48:51], v[28:31]
    v_mfma_f32_16x16x32_bf16 v[24:27], v[86:89], v[54:57], v[24:27]
    v_mfma_f32_16x16x32_bf16 v[28:31], v[86:89], v[52:55], v[28:31]
    v_mfma_f32_16x16x32_bf16 v[24:27], v[90:93], v[58:61], v[24:27]
    v_mfma_f32_16x16x32_bf16 v[28:31], v[90:93], v[56:59], v[28:31]
    buffer_load_dwordx4 v[62:65], v2, s[32:35], s76 offen offset:0 nt
    buffer_load_dwordx4 v[66:69], v2, s[32:35], s76 offen offset:128 nt
    buffer_load_dwordx4 v[70:73], v2, s[32:35], s76 offen offset:2048 nt
    buffer_load_dwordx4 v[74:77], v2, s[32:35], s76 offen offset:2176 nt
    buffer_load_dwordx4 v[78:81], v3, s[36:39], s76 offen offset:0 nt
    buffer_load_dwordx4 v[82:85], v3, s[36:39], s76 offen offset:1024 nt
    buffer_load_dwordx4 v[86:89], v3, s[36:39], s76 offen offset:2048 nt
    buffer_load_dwordx4 v[90:93], v3, s[36:39], s76 offen offset:3072 nt
    s_cmp_eq_u32 s77, 0x30000000
    s_cbranch_scc1 L_sdone
    s_waitcnt vmcnt(12)
    v_mfma_f32_16x16x32_bf16 v[16:19], v[94:97], v[32:35], 0
    v_mfma_f32_16x16x32_bf16 v[40:43], v[102:105], v[32:35], 0
    v_mfma_f32_16x16x32_bf16 v[16:19], v[98:101], v[36:39], v[16:19]
    v_mfma_f32_16x16x32_bf16 v[40:43], v[106:109], v[36:39], v[40:43]
    s_cmp_gt_i32 s64, 0
    s_cselect_b32 s77, s63, 0x30000000
    s_sub_u32 s64, s64, 1
    s_add_u32 s63, s63, 16384
    s_nop 2
    v_cndmask_b32_e64 v20, v16, v17, s[72:73]
    v_cndmask_b32_e64 v21, v18, v19, s[72:73]
    v_cndmask_b32_e64 v22, v40, v41, s[72:73]
    v_cndmask_b32_e64 v23, v42, v43, s[72:73]
    v_add_f32_dpp v20, v20, v20 quad_perm:[1,0,3,2] row_mask:0xf bank_mask:0xf
    v_add_f32_dpp v21, v21, v21 quad_perm:[1,0,3,2] row_mask:0xf bank_mask:0xf
    v_add_f32_dpp v22, v22, v22 quad_perm:[1,0,3,2] row_mask:0xf bank_mask:0xf
    v_add_f32_dpp v23, v23, v23 quad_perm:[1,0,3,2] row_mask:0xf bank_mask:0xf
    v_cvt_pk_bf16_f32 v20, 0, v20
    v_cvt_pk_bf16_f32 v21, 0, v21
    v_cvt_pk_bf16_f32 v22, 0, v22
    v_cvt_pk_bf16_f32 v23, 0, v23
    v_pk_mul_f32 v[20:21], v[20:21], s[68:69]
    v_pk_mul_f32 v[22:23], v[22:23], s[68:69]
    v_cvt_pk_bf16_f32 v20, 0, v20
    v_cvt_pk_bf16_f32 v21, 0, v21
    v_cvt_pk_bf16_f32 v22, 0, v22
    v_cvt_pk_bf16_f32 v23, 0, v23
    v_max3_f32 v11, v20, v21, v22
    v_max_f32 v11, v11, v23
    v_cmp_gt_f32 vcc, v11, v4
    s_cbranch_vccz L_nomaxb
    v_max_f32 v4, v11, v4
    v_mov_b32 v11, v4
    s_nop 1
    v_permlane16_swap_b32 v11, v4
    v_max_f32 v4, v4, v11
    v_mov_b32 v11, v4
    s_nop 1
    v_permlane32_swap_b32 v11, v4
    v_max_f32 v4, v4, v11
    v_mul_f32 v11, s70, v4
    v_sub_f32 v12, v6, v11
    v_exp_f32 v12, v12
    v_mov_b32 v6, v11
    v_pk_mul_f32 v[24:25], v[24:25], v[12:13] op_sel_hi:[1,0]
    v_pk_mul_f32 v[26:27], v[26:27], v[12:13] op_sel_hi:[1,0]
    v_pk_mul_f32 v[28:29], v[28:29], v[12:13] op_sel_hi:[1,0]
    v_pk_mul_f32 v[30:31], v[30:31], v[12:13] op_sel_hi:[1,0]
    v_pk_mul_f32 v[8:9], v[8:9], v[12:13] op_sel_hi:[1,0]
L_nomaxb:
    v_pk_fma_f32 v[20:21], v[20:21], s[70:71], v[6:7] op_sel_hi:[1,1,0] neg_lo:[0,0,1] neg_hi:[0,0,1]
    v_pk_fma_f32 v[22:23], v[22:23], s[70:71], v[6:7] op_sel_hi:[1,1,0] neg_lo:[0,0,1] neg_hi:[0,0,1]
    v_exp_f32 v20, v20
    v_exp_f32 v21, v21
    v_exp_f32 v22, v22
    v_exp_f32 v23, v23
    v_cvt_pk_bf16_f32 v16, v20, v20
    v_cvt_pk_bf16_f32 v17, v21, v21
    v_cvt_pk_bf16_f32 v18, v22, v22
    v_cvt_pk_bf16_f32 v19, v23, v23
    v_and_b32 v46, v16, v5
    v_and_b32 v47, v16, v10
    v_and_b32 v50, v17, v5
    v_and_b32 v51, v17, v10
    v_and_b32 v54, v18, v5
    v_and_b32 v55, v18, v10
    v_and_b32 v58, v19, v5
    v_and_b32 v59, v19, v10
    v_pk_add_f32 v[8:9], v[8:9], v[20:21]
    v_pk_add_f32 v[8:9], v[8:9], v[22:23]
    s_waitcnt vmcnt(8)
    v_mfma_f32_16x16x32_bf16 v[24:27], v[110:113], v[46:49], v[24:27]
    v_mfma_f32_16x16x32_bf16 v[28:31], v[110:113], v[44:47], v[28:31]
    v_mfma_f32_16x16x32_bf16 v[24:27], v[114:117], v[50:53], v[24:27]
    v_mfma_f32_16x16x32_bf16 v[28:31], v[114:117], v[48:51], v[28:31]
    v_mfma_f32_16x16x32_bf16 v[24:27], v[118:121], v[54:57], v[24:27]
    v_mfma_f32_16x16x32_bf16 v[28:31], v[118:121], v[52:55], v[28:31]
    v_mfma_f32_16x16x32_bf16 v[24:27], v[122:125], v[58:61], v[24:27]
    v_mfma_f32_16x16x32_bf16 v[28:31], v[122:125], v[56:59], v[28:31]
    buffer_load_dwordx4 v[94:97], v2, s[32:35], s77 offen offset:0 nt
    buffer_load_dwordx4 v[98:101], v2, s[32:35], s77 offen offset:128 nt
    buffer_load_dwordx4 v[102:105], v2, s[32:35], s77 offen offset:2048 nt
    buffer_load_dwordx4 v[106:109], v2, s[32:35], s77 offen offset:2176 nt
    buffer_load_dwordx4 v[110:113], v3, s[36:39], s77 offen offset:0 nt
    buffer_load_dwordx4 v[114:117], v3, s[36:39], s77 offen offset:1024 nt
    buffer_load_dwordx4 v[118:121], v3, s[36:39], s77 offen offset:2048 nt
    buffer_load_dwordx4 v[122:125], v3, s[36:39], s77 offen offset:3072 nt
    s_cmp_eq_u32 s76, 0x30000000
    s_cbranch_scc0 L_loop
L_sdone:
    v_add_f32 v8, v8, v9
    v_mov_b32 v11, v8
    s_nop 1
    v_permlane16_swap_b32 v11, v8
    v_add_f32 v8, v8, v11
    v_mov_b32 v11, v8
    s_nop 1
    v_permlane32_swap_b32 v11, v8
    v_add_f32 v8, v8, v11
    v_mov_b32 v7, v8
    s_lshl_b32 s67, s60, 11
    v_bfe_u32 v11, v1, 2, 2
    v_lshlrev_b32 v20, 9, v11
    v_lshrrev_b32 v12, 4, v1
    v_lshl_add_u32 v20, v12, 6, v20
    v_and_b32 v12, 3, v1
    v_lshl_add_u32 v20, v12, 4, v20
    v_add_u32 v20, s67, v20
    s_lshl_b32 s67, s60, 5
    v_lshlrev_b32 v11, 3, v11
    v_add_u32 v11, s67, v11
    ds_write_b128 v20, v[24:27] offset:1024
    ds_write_b128 v20, v[28:31] offset:1280
    ds_write_b64 v11, v[6:7] offset:9216
    s_waitcnt lgkmcnt(0)
    s_barrier
    s_endpgm
L_service:
    s_setprio 3
    v_lshlrev_b32 v2, 4, v1
    s_and_b32 s76, s62, 7
    s_lshl_b32 s76, s76, 2
    s_lshr_b32 s77, s62, 3
    s_or_b32 s76, s76, s77
    s_lshl_b32 s77, s61, 5
    s_add_u32 s76, s76, s77
    v_lshrrev_b32 v3, 1, v1
    v_lshlrev_b32 v8, 13, v3
    v_and_b32 v9, 1, v1
    v_lshl_add_u32 v8, v9, 4, v8
    s_lshl_b32 s74, s76, 5
    s_lshl_b32 s75, s60, 20
    s_add_u32 s74, s74, s75
    s_lshl_b32 s77, s2, 1
    s_add_u32 s77, s77, s60
    s_lshl_b32 s77, s77, 10
    s_add_u32 s77, s77, 0x40000
    s_lshl_b32 s75, s2, 10
    s_add_u32 s75, s75, 0x8000
    s_cmp_lt_u32 s2, 144
    s_cselect_b32 s75, s75, 0x30000000
    s_cmp_eq_u32 s60, 2
    s_cselect_b32 s77, s75, s77
    s_lshl_b32 s75, s61, 10
    s_add_u32 s75, s75, 0x4000
    s_cmp_eq_u32 s62, 0
    s_cselect_b32 s75, s75, 0x30000000
    s_cmp_eq_u32 s60, 3
    s_cselect_b32 s77, s75, s77
    v_mov_b32 v12, -1
    v_mov_b32 v13, -1
    v_mov_b32 v14, -1
    v_mov_b32 v15, -1
    s_waitcnt lgkmcnt(0)
    s_mov_b32 s40, s28
    s_and_b32 s41, s29, 0xffff
    s_mov_b32 s42, 0x20000000
    s_mov_b32 s43, 0x00020000
    buffer_store_dwordx4 v[12:15], v2, s[40:43], s77 offen sc1
    s_mov_b32 s48, s10
    s_and_b32 s49, s11, 0xffff
    s_mov_b32 s50, 0x400000
    s_mov_b32 s51, 0x00020000
    global_load_dwordx4 v[4:7], v2, s[4:5]
    buffer_load_dwordx4 v[64:67], v8, s[48:51], s74 offen nt
    s_add_u32 s74, s74, 0x40000
    buffer_load_dwordx4 v[68:71], v8, s[48:51], s74 offen nt
    s_add_u32 s74, s74, 0x40000
    buffer_load_dwordx4 v[72:75], v8, s[48:51], s74 offen nt
    s_add_u32 s74, s74, 0x40000
    buffer_load_dwordx4 v[76:79], v8, s[48:51], s74 offen nt
    v_mov_b32 v12, -1
    v_lshlrev_b32 v10, 2, v1
    ds_write_b32 v10, v12 offset:18432
    s_waitcnt lgkmcnt(0)
    s_barrier
    s_load_dword s63, s[28:29], 0x7000
    s_mov_b32 s72, 0
    s_mul_i32 s73, s61, 15
    s_add_u32 s73, s73, s62
    s_cmp_lt_u32 s62, 15
    s_cbranch_scc0 L_r1
    s_mov_b32 s72, 2
    s_cmp_lt_u32 s73, 64
    s_cbranch_scc1 L_r2
    s_mov_b32 s72, 3
    s_sub_u32 s73, s73, 64
    s_branch L_r2
L_r1:
    s_cmp_ge_u32 s62, 30
    s_cbranch_scc0 L_r2
    s_mov_b32 s72, 4
    s_lshl_b32 s73, s61, 1
    s_add_u32 s73, s73, s62
    s_sub_u32 s73, s73, 30
L_r2:
    s_mov_b32 s44, s24
    s_and_b32 s45, s25, 0xffff
    s_mov_b32 s46, 0x400
    s_mov_b32 s47, 0x00020000
    s_mov_b32 s52, s12
    s_and_b32 s53, s13, 0xffff
    s_mov_b32 s54, 0x400000
    s_mov_b32 s55, 0x00020000
    s_mov_b32 s56, s16
    s_and_b32 s57, s17, 0xffff
    s_mov_b32 s58, 0x1c0000
    s_mov_b32 s59, 0x00020000
    s_mov_b32 s32, s20
    s_and_b32 s33, s21, 0xffff
    s_mov_b32 s34, 0x1c0000
    s_mov_b32 s35, 0x00020000
    v_lshlrev_b32 v10, 5, v1
    s_lshl_b32 s74, s60, 9
    v_lshl_add_u32 v3, v3, 2, s74
    v_lshrrev_b32 v11, 4, v1
    v_lshlrev_b32 v11, 3, v11
    v_lshl_add_u32 v11, v9, 5, v11
    s_lshl_b32 s74, s60, 6
    v_add_u32 v11, s74, v11
    s_waitcnt vmcnt(4)
    v_lshlrev_b32 v16, 16, v4
    v_and_b32 v17, 0xffff0000, v4
    v_lshlrev_b32 v18, 16, v5
    v_and_b32 v19, 0xffff0000, v5
    v_lshlrev_b32 v20, 16, v6
    v_and_b32 v21, 0xffff0000, v6
    v_lshlrev_b32 v22, 16, v7
    v_and_b32 v23, 0xffff0000, v7
    v_pk_add_f32 v[24:25], v[16:17], v[18:19]
    v_pk_add_f32 v[26:27], v[20:21], v[22:23]
    v_pk_add_f32 v[24:25], v[24:25], v[26:27]
    v_add_f32 v24, v24, v25
    s_nop 1
    v_add_f32_dpp v24, v24, v24 row_ror:8 row_mask:0xf bank_mask:0xf
    s_nop 1
    v_add_f32_dpp v24, v24, v24 row_ror:4 row_mask:0xf bank_mask:0xf
    s_nop 1
    v_add_f32_dpp v24, v24, v24 row_ror:2 row_mask:0xf bank_mask:0xf
    s_nop 1
    v_add_f32_dpp v24, v24, v24 row_ror:1 row_mask:0xf bank_mask:0xf
    v_mov_b32 v25, v24
    s_nop 1
    v_permlane16_swap_b32 v25, v24
    v_add_f32 v24, v24, v25
    v_mov_b32 v25, v24
    s_nop 1
    v_permlane32_swap_b32 v25, v24
    v_add_f32 v24, v24, v25
    v_mul_f32 v24, 0x3b000000, v24
    v_pk_add_f32 v[28:29], v[16:17], v[24:25] op_sel_hi:[1,0] neg_lo:[0,1] neg_hi:[0,1]
    v_pk_add_f32 v[30:31], v[18:19], v[24:25] op_sel_hi:[1,0] neg_lo:[0,1] neg_hi:[0,1]
    v_pk_add_f32 v[32:33], v[20:21], v[24:25] op_sel_hi:[1,0] neg_lo:[0,1] neg_hi:[0,1]
    v_pk_add_f32 v[34:35], v[22:23], v[24:25] op_sel_hi:[1,0] neg_lo:[0,1] neg_hi:[0,1]
    v_pk_mul_f32 v[26:27], v[28:29], v[28:29]
    v_pk_fma_f32 v[26:27], v[30:31], v[30:31], v[26:27]
    v_pk_fma_f32 v[26:27], v[32:33], v[32:33], v[26:27]
    v_pk_fma_f32 v[26:27], v[34:35], v[34:35], v[26:27]
    v_add_f32 v26, v26, v27
    v_cvt_pk_bf16_f32 v24, 0, v24
    s_nop 0
    v_add_f32_dpp v26, v26, v26 row_ror:8 row_mask:0xf bank_mask:0xf
    s_nop 1
    v_add_f32_dpp v26, v26, v26 row_ror:4 row_mask:0xf bank_mask:0xf
    s_nop 1
    v_add_f32_dpp v26, v26, v26 row_ror:2 row_mask:0xf bank_mask:0xf
    s_nop 1
    v_add_f32_dpp v26, v26, v26 row_ror:1 row_mask:0xf bank_mask:0xf
    v_mov_b32 v27, v26
    s_nop 1
    v_permlane16_swap_b32 v27, v26
    v_add_f32 v26, v26, v27
    v_mov_b32 v27, v26
    s_nop 1
    v_permlane32_swap_b32 v27, v26
    v_add_f32 v26, v26, v27
    v_pk_add_f32 v[16:17], v[16:17], v[24:25] op_sel_hi:[1,0] neg_lo:[0,1] neg_hi:[0,1]
    v_pk_add_f32 v[18:19], v[18:19], v[24:25] op_sel_hi:[1,0] neg_lo:[0,1] neg_hi:[0,1]
    v_pk_add_f32 v[20:21], v[20:21], v[24:25] op_sel_hi:[1,0] neg_lo:[0,1] neg_hi:[0,1]
    v_pk_add_f32 v[22:23], v[22:23], v[24:25] op_sel_hi:[1,0] neg_lo:[0,1] neg_hi:[0,1]
    v_mul_f32 v26, 0x3b000000, v26
    v_cvt_pk_bf16_f32 v26, 0, v26
    v_add_f32 v26, 0x3727c5ac, v26
    v_cvt_pk_bf16_f32 v26, 0, v26
    v_sqrt_f32 v26, v26
    v_cvt_pk_bf16_f32 v16, 0, v16
    v_cvt_pk_bf16_f32 v17, 0, v17
    v_cvt_pk_bf16_f32 v18, 0, v18
    v_cvt_pk_bf16_f32 v19, 0, v19
    v_cvt_pk_bf16_f32 v26, 0, v26
    v_rcp_f32 v26, v26
    v_cvt_pk_bf16_f32 v20, 0, v20
    v_cvt_pk_bf16_f32 v21, 0, v21
    v_cvt_pk_bf16_f32 v22, 0, v22
    v_cvt_pk_bf16_f32 v23, 0, v23
    v_pk_mul_f32 v[16:17], v[16:17], v[26:27] op_sel_hi:[1,0]
    v_pk_mul_f32 v[18:19], v[18:19], v[26:27] op_sel_hi:[1,0]
    v_pk_mul_f32 v[20:21], v[20:21], v[26:27] op_sel_hi:[1,0]
    v_pk_mul_f32 v[22:23], v[22:23], v[26:27] op_sel_hi:[1,0]
    v_cvt_pk_bf16_f32 v16, 0, v16
    v_cvt_pk_bf16_f32 v17, 0, v17
    v_cvt_pk_bf16_f32 v18, 0, v18
    v_cvt_pk_bf16_f32 v19, 0, v19
    v_cvt_pk_bf16_f32 v20, 0, v20
    v_cvt_pk_bf16_f32 v21, 0, v21
    v_cvt_pk_bf16_f32 v22, 0, v22
    v_cvt_pk_bf16_f32 v23, 0, v23
    ds_write_b128 v10, v[16:19] offset:16384
    ds_write_b128 v10, v[20:23] offset:16400
    ds_read_b32 v32, v3 offset:16384
    ds_read_b32 v34, v3 offset:16512
    ds_read_b32 v36, v3 offset:16640
    ds_read_b32 v38, v3 offset:16768
    s_waitcnt vmcnt(3)
    v_lshlrev_b32 v24, 16, v64
    v_and_b32 v25, 0xffff0000, v64
    v_lshlrev_b32 v26, 16, v65
    v_and_b32 v27, 0xffff0000, v65
    v_lshlrev_b32 v28, 16, v66
    v_and_b32 v29, 0xffff0000, v66
    v_lshlrev_b32 v30, 16, v67
    v_and_b32 v31, 0xffff0000, v67
    s_waitcnt lgkmcnt(0)
    s_mul_i32 s63, s63, 0x9e3779b1
    s_add_u32 s63, s63, 0x7f4a7c15
    v_pk_mul_f32 v[16:17], v[24:25], v[32:33] op_sel_hi:[1,0]
    v_pk_mul_f32 v[18:19], v[26:27], v[32:33] op_sel_hi:[1,0]
    v_pk_mul_f32 v[20:21], v[28:29], v[32:33] op_sel_hi:[1,0]
    v_pk_mul_f32 v[22:23], v[30:31], v[32:33] op_sel_hi:[1,0]
    s_waitcnt vmcnt(2)
    v_lshlrev_b32 v24, 16, v68
    v_and_b32 v25, 0xffff0000, v68
    v_lshlrev_b32 v26, 16, v69
    v_and_b32 v27, 0xffff0000, v69
    v_lshlrev_b32 v28, 16, v70
    v_and_b32 v29, 0xffff0000, v70
    v_lshlrev_b32 v30, 16, v71
    v_and_b32 v31, 0xffff0000, v71
    v_pk_fma_f32 v[16:17], v[24:25], v[34:35], v[16:17] op_sel_hi:[1,0,1]
    v_pk_fma_f32 v[18:19], v[26:27], v[34:35], v[18:19] op_sel_hi:[1,0,1]
    v_pk_fma_f32 v[20:21], v[28:29], v[34:35], v[20:21] op_sel_hi:[1,0,1]
    v_pk_fma_f32 v[22:23], v[30:31], v[34:35], v[22:23] op_sel_hi:[1,0,1]
    s_waitcnt vmcnt(1)
    v_lshlrev_b32 v24, 16, v72
    v_and_b32 v25, 0xffff0000, v72
    v_lshlrev_b32 v26, 16, v73
    v_and_b32 v27, 0xffff0000, v73
    v_lshlrev_b32 v28, 16, v74
    v_and_b32 v29, 0xffff0000, v74
    v_lshlrev_b32 v30, 16, v75
    v_and_b32 v31, 0xffff0000, v75
    v_pk_fma_f32 v[16:17], v[24:25], v[36:37], v[16:17] op_sel_hi:[1,0,1]
    v_pk_fma_f32 v[18:19], v[26:27], v[36:37], v[18:19] op_sel_hi:[1,0,1]
    v_pk_fma_f32 v[20:21], v[28:29], v[36:37], v[20:21] op_sel_hi:[1,0,1]
    v_pk_fma_f32 v[22:23], v[30:31], v[36:37], v[22:23] op_sel_hi:[1,0,1]
    s_waitcnt vmcnt(0)
    v_lshlrev_b32 v24, 16, v76
    v_and_b32 v25, 0xffff0000, v76
    v_lshlrev_b32 v26, 16, v77
    v_and_b32 v27, 0xffff0000, v77
    v_lshlrev_b32 v28, 16, v78
    v_and_b32 v29, 0xffff0000, v78
    v_lshlrev_b32 v30, 16, v79
    v_and_b32 v31, 0xffff0000, v79
    v_pk_fma_f32 v[16:17], v[24:25], v[38:39], v[16:17] op_sel_hi:[1,0,1]
    v_pk_fma_f32 v[18:19], v[26:27], v[38:39], v[18:19] op_sel_hi:[1,0,1]
    v_pk_fma_f32 v[20:21], v[28:29], v[38:39], v[20:21] op_sel_hi:[1,0,1]
    v_pk_fma_f32 v[22:23], v[30:31], v[38:39], v[22:23] op_sel_hi:[1,0,1]
    v_permlane16_swap_b32 v16, v18
    v_permlane16_swap_b32 v17, v19
    v_permlane16_swap_b32 v20, v22
    v_permlane16_swap_b32 v21, v23
    v_add_f32 v16, v16, v18
    v_add_f32 v17, v17, v19
    v_add_f32 v20, v20, v22
    v_add_f32 v21, v21, v23
    s_nop 0
    v_permlane32_swap_b32 v16, v20
    v_permlane32_swap_b32 v17, v21
    v_add_f32 v16, v16, v20
    v_add_f32 v17, v17, v21
    s_nop 0
    v_add_f32_dpp v16, v16, v16 row_ror:8 row_mask:0xf bank_mask:0xf
    v_add_f32_dpp v17, v17, v17 row_ror:8 row_mask:0xf bank_mask:0xf
    s_nop 0
    v_add_f32_dpp v16, v16, v16 row_ror:4 row_mask:0xf bank_mask:0xf
    v_add_f32_dpp v17, v17, v17 row_ror:4 row_mask:0xf bank_mask:0xf
    s_nop 0
    v_add_f32_dpp v16, v16, v16 row_ror:2 row_mask:0xf bank_mask:0xf
    v_add_f32_dpp v17, v17, v17 row_ror:2 row_mask:0xf bank_mask:0xf
    s_waitcnt vmcnt(0)
    ds_write_b64 v11, v[16:17] offset:18432
    s_cmp_eq_u32 s60, 0
    s_cbranch_scc0 L_q2
    v_and_b32 v11, 3, v1
    v_lshlrev_b32 v11, 4, v11
    s_lshl_b32 s76, s76, 6
    s_lshl_b32 s74, s61, 11
    s_mov_b32 s79, 65536
L_qp:
    ds_read_b128 v[16:19], v11 offset:18432
    ds_read_b128 v[20:23], v11 offset:18496
    ds_read_b128 v[24:27], v11 offset:18560
    ds_read_b128 v[28:31], v11 offset:18624
    s_waitcnt lgkmcnt(0)
    v_max3_u32 v12, v20, v21, v22
    v_max3_u32 v12, v12, v23, v24
    v_max3_u32 v12, v12, v25, v26
    v_max3_u32 v12, v12, v27, v28
    v_max3_u32 v12, v12, v29, v30
    v_max_u32 v12, v12, v31
    v_cmp_eq_u32 vcc, -1, v12
    s_cbranch_vccz L_qp_ok
    s_sub_u32 s79, s79, 1
    s_cmp_lg_u32 s79, 0
    s_cbranch_scc1 L_qp
L_qp_ok:
    v_pk_add_f32 v[16:17], v[16:17], v[20:21]
    v_pk_add_f32 v[18:19], v[18:19], v[22:23]
    v_pk_add_f32 v[24:25], v[24:25], v[28:29]
    v_pk_add_f32 v[26:27], v[26:27], v[30:31]
    v_pk_add_f32 v[16:17], v[16:17], v[24:25]
    v_pk_add_f32 v[18:19], v[18:19], v[26:27]
    v_cvt_pk_bf16_f32 v16, v16, v17
    v_cvt_pk_bf16_f32 v18, v18, v19
    v_mov_b32 v17, s63
    v_mov_b32 v19, s63
    s_mov_b64 exec, 15
    buffer_store_dwordx4 v[16:19], v11, s[40:43], s76 offen sc1
    s_mov_b64 exec, -1
    s_mov_b32 s79, 65536
L_pq:
    buffer_load_dwordx4 v[16:19], v10, s[40:43], s74 offen sc1
    buffer_load_dwordx4 v[20:23], v10, s[40:43], s74 offen offset:16 sc1
    s_waitcnt vmcnt(0)
    v_xor_b32 v17, s63, v17
    v_xor_b32 v19, s63, v19
    v_xor_b32 v21, s63, v21
    v_xor_b32 v23, s63, v23
    v_or3_b32 v17, v17, v19, v21
    v_or_b32 v17, v17, v23
    v_cmp_ne_u32 vcc, 0, v17
    s_cbranch_vccz L_pq_ok
    s_sub_u32 s79, s79, 1
    s_cmp_lg_u32 s79, 0
    s_cbranch_scc1 L_pq
L_pq_ok:
    v_mov_b32 v17, v18
    v_mov_b32 v18, v20
    v_mov_b32 v19, v22
    ds_write_b128 v2, v[16:19] offset:0
L_q2:
    s_waitcnt lgkmcnt(0)
    s_setprio 0
    s_barrier
    s_cmp_eq_u32 s72, 2
    s_cbranch_scc0 L_pf3
    v_lshrrev_b32 v3, 2, v1
    v_lshlrev_b32 v3, 10, v3
    v_and_b32 v4, 3, v1
    v_lshl_add_u32 v3, v4, 4, v3
    s_lshr_b32 s74, s73, 2
    s_lshl_b32 s74, s74, 18
    s_and_b32 s75, s73, 3
    s_lshl_b32 s75, s75, 8
    s_add_u32 s74, s74, s75
    s_lshl_b32 s75, s60, 6
    s_add_u32 s74, s74, s75
    buffer_load_dwordx4 v[64:67], v3, s[52:55], s74 offen nt
    s_add_u32 s74, s74, 16384
    buffer_load_dwordx4 v[68:71], v3, s[52:55], s74 offen nt
    s_add_u32 s74, s74, 16384
    buffer_load_dwordx4 v[72:75], v3, s[52:55], s74 offen nt
    s_add_u32 s74, s74, 16384
    buffer_load_dwordx4 v[76:79], v3, s[52:55], s74 offen nt
    s_add_u32 s74, s74, 16384
    buffer_load_dwordx4 v[80:83], v3, s[52:55], s74 offen nt
    s_add_u32 s74, s74, 16384
    buffer_load_dwordx4 v[84:87], v3, s[52:55], s74 offen nt
    s_add_u32 s74, s74, 16384
    buffer_load_dwordx4 v[88:91], v3, s[52:55], s74 offen nt
    s_add_u32 s74, s74, 16384
    buffer_load_dwordx4 v[92:95], v3, s[52:55], s74 offen nt
    s_add_u32 s74, s74, 16384
    buffer_load_dwordx4 v[96:99], v3, s[52:55], s74 offen nt
    s_add_u32 s74, s74, 16384
    buffer_load_dwordx4 v[100:103], v3, s[52:55], s74 offen nt
    s_add_u32 s74, s74, 16384
    buffer_load_dwordx4 v[104:107], v3, s[52:55], s74 offen nt
    s_add_u32 s74, s74, 16384
    buffer_load_dwordx4 v[108:111], v3, s[52:55], s74 offen nt
    s_add_u32 s74, s74, 16384
    buffer_load_dwordx4 v[112:115], v3, s[52:55], s74 offen nt
    s_add_u32 s74, s74, 16384
    buffer_load_dwordx4 v[116:119], v3, s[52:55], s74 offen nt
    s_add_u32 s74, s74, 16384
    buffer_load_dwordx4 v[120:123], v3, s[52:55], s74 offen nt
    s_add_u32 s74, s74, 16384
    buffer_load_dwordx4 v[124:127], v3, s[52:55], s74 offen nt
    s_add_u32 s74, s74, 16384
    s_branch L_pfe
L_pf3:
    s_cmp_eq_u32 s72, 3
    s_cbranch_scc0 L_pfe
    v_lshrrev_b32 v3, 2, v1
    v_mul_u32_u24 v3, 3584, v3
    v_and_b32 v4, 3, v1
    v_lshl_add_u32 v3, v4, 4, v3
    s_mul_i32 s74, s60, 458752
    s_lshl_b32 s75, s73, 6
    s_add_u32 s74, s74, s75
    buffer_load_dwordx4 v[64:67], v3, s[56:59], s74 offen nt
    s_add_u32 s74, s74, 57344
    buffer_load_dwordx4 v[68:71], v3, s[56:59], s74 offen nt
    s_add_u32 s74, s74, 57344
    buffer_load_dwordx4 v[72:75], v3, s[56:59], s74 offen nt
    s_add_u32 s74, s74, 57344
    buffer_load_dwordx4 v[76:79], v3, s[56:59], s74 offen nt
    s_add_u32 s74, s74, 57344
    buffer_load_dwordx4 v[80:83], v3, s[56:59], s74 offen nt
    s_add_u32 s74, s74, 57344
    buffer_load_dwordx4 v[84:87], v3, s[56:59], s74 offen nt
    s_add_u32 s74, s74, 57344
    buffer_load_dwordx4 v[88:91], v3, s[56:59], s74 offen nt
    s_add_u32 s74, s74, 57344
    buffer_load_dwordx4 v[92:95], v3, s[56:59], s74 offen nt
    s_add_u32 s74, s74, 57344
    v_lshrrev_b32 v3, 4, v1
    v_lshlrev_b32 v3, 10, v3
    v_and_b32 v4, 15, v1
    v_lshl_add_u32 v3, v4, 4, v3
    s_lshl_b32 s74, s73, 15
    s_lshl_b32 s75, s60, 8
    s_add_u32 s74, s74, s75
    buffer_load_dwordx4 v[96:99], v3, s[32:35], s74 offen nt
    s_add_u32 s74, s74, 4096
    buffer_load_dwordx4 v[100:103], v3, s[32:35], s74 offen nt
    s_add_u32 s74, s74, 4096
    buffer_load_dwordx4 v[104:107], v3, s[32:35], s74 offen nt
    s_add_u32 s74, s74, 4096
    buffer_load_dwordx4 v[108:111], v3, s[32:35], s74 offen nt
    s_add_u32 s74, s74, 4096
    buffer_load_dwordx4 v[112:115], v3, s[32:35], s74 offen nt
    s_add_u32 s74, s74, 4096
    buffer_load_dwordx4 v[116:119], v3, s[32:35], s74 offen nt
    s_add_u32 s74, s74, 4096
    buffer_load_dwordx4 v[120:123], v3, s[32:35], s74 offen nt
    s_add_u32 s74, s74, 4096
    buffer_load_dwordx4 v[124:127], v3, s[32:35], s74 offen nt
    s_add_u32 s74, s74, 4096
L_pfe:
L_stage:
    s_lshl_b32 s74, s60, 14
    s_add_u32 s74, s74, 20480
    v_add_u32 v3, s74, v2
    v_lshrrev_b32 v5, 4, v1
    v_and_b32 v6, 15, v1
    s_cmp_eq_u32 s72, 2
    s_cbranch_scc1 L_st2
    s_cmp_eq_u32 s72, 3
    s_cbranch_scc1 L_st3
    s_cmp_eq_u32 s72, 4
    s_cbranch_scc0 L_rdy
    v_and_b32 v7, 7, v1
    v_lshlrev_b32 v7, 3, v7
    s_lshl_b32 s74, s73, 6
    v_add_u32 v7, s74, v7
    global_load_dwordx2 v[40:41], v7, s[4:5]
    global_load_dwordx2 v[42:43], v7, s[22:23]
    s_branch L_ste
L_st2:
    s_waitcnt vmcnt(15)
    ds_write_b128 v3, v[64:67] offset:0
    s_waitcnt vmcnt(14)
    ds_write_b128 v3, v[68:71] offset:1024
    s_waitcnt vmcnt(13)
    ds_write_b128 v3, v[72:75] offset:2048
    s_waitcnt vmcnt(12)
    ds_write_b128 v3, v[76:79] offset:3072
    s_waitcnt vmcnt(11)
    ds_write_b128 v3, v[80:83] offset:4096
    s_waitcnt vmcnt(10)
    ds_write_b128 v3, v[84:87] offset:5120
    s_waitcnt vmcnt(9)
    ds_write_b128 v3, v[88:91] offset:6144
    s_waitcnt vmcnt(8)
    ds_write_b128 v3, v[92:95] offset:7168
    s_waitcnt vmcnt(7)
    ds_write_b128 v3, v[96:99] offset:8192
    s_waitcnt vmcnt(6)
    ds_write_b128 v3, v[100:103] offset:9216
    s_waitcnt vmcnt(5)
    ds_write_b128 v3, v[104:107] offset:10240
    s_waitcnt vmcnt(4)
    ds_write_b128 v3, v[108:111] offset:11264
    s_waitcnt vmcnt(3)
    ds_write_b128 v3, v[112:115] offset:12288
    s_waitcnt vmcnt(2)
    ds_write_b128 v3, v[116:119] offset:13312
    s_waitcnt vmcnt(1)
    ds_write_b128 v3, v[120:123] offset:14336
    s_waitcnt vmcnt(0)
    ds_write_b128 v3, v[124:127] offset:15360
    s_waitcnt lgkmcnt(0)
    v_lshrrev_b32 v7, 1, v5
    v_lshlrev_b32 v7, 11, v7
    v_and_b32 v8, 1, v5
    v_lshl_add_u32 v7, v8, 7, v7
    v_lshl_add_u32 v7, v6, 1, v7
    v_add_u32 v7, s74, v7
    ds_read_u16 v64, v7 offset:0
    ds_read_u16 v65, v7 offset:512
    ds_read_u16 v66, v7 offset:1024
    ds_read_u16 v67, v7 offset:1536
    ds_read_u16 v68, v7 offset:64
    ds_read_u16 v69, v7 offset:576
    ds_read_u16 v70, v7 offset:1088
    ds_read_u16 v71, v7 offset:1600
    s_waitcnt lgkmcnt(0)
    v_lshl_or_b32 v128, v65, 16, v64
    v_lshl_or_b32 v129, v67, 16, v66
    v_lshl_or_b32 v130, v69, 16, v68
    v_lshl_or_b32 v131, v71, 16, v70
    ds_read_u16 v64, v7 offset:32
    ds_read_u16 v65, v7 offset:544
    ds_read_u16 v66, v7 offset:1056
    ds_read_u16 v67, v7 offset:1568
    ds_read_u16 v68, v7 offset:96
    ds_read_u16 v69, v7 offset:608
    ds_read_u16 v70, v7 offset:1120
    ds_read_u16 v71, v7 offset:1632
    s_waitcnt lgkmcnt(0)
    v_lshl_or_b32 v132, v65, 16, v64
    v_lshl_or_b32 v133, v67, 16, v66
    v_lshl_or_b32 v134, v69, 16, v68
    v_lshl_or_b32 v135, v71, 16, v70
    ds_read_u16 v64, v7 offset:4096
    ds_read_u16 v65, v7 offset:4608
    ds_read_u16 v66, v7 offset:5120
    ds_read_u16 v67, v7 offset:5632
    ds_read_u16 v68, v7 offset:4160
    ds_read_u16 v69, v7 offset:4672
    ds_read_u16 v70, v7 offset:5184
    ds_read_u16 v71, v7 offset:5696
    s_waitcnt lgkmcnt(0)
    v_lshl_or_b32 v136, v65, 16, v64
    v_lshl_or_b32 v137, v67, 16, v66
    v_lshl_or_b32 v138, v69, 16, v68
    v_lshl_or_b32 v139, v71, 16, v70
    ds_read_u16 v64, v7 offset:4128
    ds_read_u16 v65, v7 offset:4640
    ds_read_u16 v66, v7 offset:5152
    ds_read_u16 v67, v7 offset:5664
    ds_read_u16 v68, v7 offset:4192
    ds_read_u16 v69, v7 offset:4704
    ds_read_u16 v70, v7 offset:5216
    ds_read_u16 v71, v7 offset:5728
    s_waitcnt lgkmcnt(0)
    v_lshl_or_b32 v140, v65, 16, v64
    v_lshl_or_b32 v141, v67, 16, v66
    v_lshl_or_b32 v142, v69, 16, v68
    v_lshl_or_b32 v143, v71, 16, v70
    ds_read_u16 v64, v7 offset:256
    ds_read_u16 v65, v7 offset:768
    ds_read_u16 v66, v7 offset:1280
    ds_read_u16 v67, v7 offset:1792
    ds_read_u16 v68, v7 offset:320
    ds_read_u16 v69, v7 offset:832
    ds_read_u16 v70, v7 offset:1344
    ds_read_u16 v71, v7 offset:1856
    s_waitcnt lgkmcnt(0)
    v_lshl_or_b32 v144, v65, 16, v64
    v_lshl_or_b32 v145, v67, 16, v66
    v_lshl_or_b32 v146, v69, 16, v68
    v_lshl_or_b32 v147, v71, 16, v70
    ds_read_u16 v64, v7 offset:288
    ds_read_u16 v65, v7 offset:800
    ds_read_u16 v66, v7 offset:1312
    ds_read_u16 v67, v7 offset:1824
    ds_read_u16 v68, v7 offset:352
    ds_read_u16 v69, v7 offset:864
    ds_read_u16 v70, v7 offset:1376
    ds_read_u16 v71, v7 offset:1888
    s_waitcnt lgkmcnt(0)
    v_lshl_or_b32 v148, v65, 16, v64
    v_lshl_or_b32 v149, v67, 16, v66
    v_lshl_or_b32 v150, v69, 16, v68
    v_lshl_or_b32 v151, v71, 16, v70
    ds_read_u16 v64, v7 offset:4352
    ds_read_u16 v65, v7 offset:4864
    ds_read_u16 v66, v7 offset:5376
    ds_read_u16 v67, v7 offset:5888
    ds_read_u16 v68, v7 offset:4416
    ds_read_u16 v69, v7 offset:4928
    ds_read_u16 v70, v7 offset:5440
    ds_read_u16 v71, v7 offset:5952
    s_waitcnt lgkmcnt(0)
    v_lshl_or_b32 v152, v65, 16, v64
    v_lshl_or_b32 v153, v67, 16, v66
    v_lshl_or_b32 v154, v69, 16, v68
    v_lshl_or_b32 v155, v71, 16, v70
    ds_read_u16 v64, v7 offset:4384
    ds_read_u16 v65, v7 offset:4896
    ds_read_u16 v66, v7 offset:5408
    ds_read_u16 v67, v7 offset:5920
    ds_read_u16 v68, v7 offset:4448
    ds_read_u16 v69, v7 offset:4960
    ds_read_u16 v70, v7 offset:5472
    ds_read_u16 v71, v7 offset:5984
    s_waitcnt lgkmcnt(0)
    v_lshl_or_b32 v156, v65, 16, v64
    v_lshl_or_b32 v157, v67, 16, v66
    v_lshl_or_b32 v158, v69, 16, v68
    v_lshl_or_b32 v159, v71, 16, v70
    ds_read_u16 v64, v7 offset:8192
    ds_read_u16 v65, v7 offset:8704
    ds_read_u16 v66, v7 offset:9216
    ds_read_u16 v67, v7 offset:9728
    ds_read_u16 v68, v7 offset:8256
    ds_read_u16 v69, v7 offset:8768
    ds_read_u16 v70, v7 offset:9280
    ds_read_u16 v71, v7 offset:9792
    s_waitcnt lgkmcnt(0)
    v_lshl_or_b32 v160, v65, 16, v64
    v_lshl_or_b32 v161, v67, 16, v66
    v_lshl_or_b32 v162, v69, 16, v68
    v_lshl_or_b32 v163, v71, 16, v70
    ds_read_u16 v64, v7 offset:8224
    ds_read_u16 v65, v7 offset:8736
    ds_read_u16 v66, v7 offset:9248
    ds_read_u16 v67, v7 offset:9760
    ds_read_u16 v68, v7 offset:8288
    ds_read_u16 v69, v7 offset:8800
    ds_read_u16 v70, v7 offset:9312
    ds_read_u16 v71, v7 offset:9824
    s_waitcnt lgkmcnt(0)
    v_lshl_or_b32 v164, v65, 16, v64
    v_lshl_or_b32 v165, v67, 16, v66
    v_lshl_or_b32 v166, v69, 16, v68
    v_lshl_or_b32 v167, v71, 16, v70
    ds_read_u16 v64, v7 offset:12288
    ds_read_u16 v65, v7 offset:12800
    ds_read_u16 v66, v7 offset:13312
    ds_read_u16 v67, v7 offset:13824
    ds_read_u16 v68, v7 offset:12352
    ds_read_u16 v69, v7 offset:12864
    ds_read_u16 v70, v7 offset:13376
    ds_read_u16 v71, v7 offset:13888
    s_waitcnt lgkmcnt(0)
    v_lshl_or_b32 v168, v65, 16, v64
    v_lshl_or_b32 v169, v67, 16, v66
    v_lshl_or_b32 v170, v69, 16, v68
    v_lshl_or_b32 v171, v71, 16, v70
    ds_read_u16 v64, v7 offset:12320
    ds_read_u16 v65, v7 offset:12832
    ds_read_u16 v66, v7 offset:13344
    ds_read_u16 v67, v7 offset:13856
    ds_read_u16 v68, v7 offset:12384
    ds_read_u16 v69, v7 offset:12896
    ds_read_u16 v70, v7 offset:13408
    ds_read_u16 v71, v7 offset:13920
    s_waitcnt lgkmcnt(0)
    v_lshl_or_b32 v172, v65, 16, v64
    v_lshl_or_b32 v173, v67, 16, v66
    v_lshl_or_b32 v174, v69, 16, v68
    v_lshl_or_b32 v175, v71, 16, v70
    ds_read_u16 v64, v7 offset:8448
    ds_read_u16 v65, v7 offset:8960
    ds_read_u16 v66, v7 offset:9472
    ds_read_u16 v67, v7 offset:9984
    ds_read_u16 v68, v7 offset:8512
    ds_read_u16 v69, v7 offset:9024
    ds_read_u16 v70, v7 offset:9536
    ds_read_u16 v71, v7 offset:10048
    s_waitcnt lgkmcnt(0)
    v_lshl_or_b32 v176, v65, 16, v64
    v_lshl_or_b32 v177, v67, 16, v66
    v_lshl_or_b32 v178, v69, 16, v68
    v_lshl_or_b32 v179, v71, 16, v70
    ds_read_u16 v64, v7 offset:8480
    ds_read_u16 v65, v7 offset:8992
    ds_read_u16 v66, v7 offset:9504
    ds_read_u16 v67, v7 offset:10016
    ds_read_u16 v68, v7 offset:8544
    ds_read_u16 v69, v7 offset:9056
    ds_read_u16 v70, v7 offset:9568
    ds_read_u16 v71, v7 offset:10080
    s_waitcnt lgkmcnt(0)
    v_lshl_or_b32 v180, v65, 16, v64
    v_lshl_or_b32 v181, v67, 16, v66
    v_lshl_or_b32 v182, v69, 16, v68
    v_lshl_or_b32 v183, v71, 16, v70
    ds_read_u16 v64, v7 offset:12544
    ds_read_u16 v65, v7 offset:13056
    ds_read_u16 v66, v7 offset:13568
    ds_read_u16 v67, v7 offset:14080
    ds_read_u16 v68, v7 offset:12608
    ds_read_u16 v69, v7 offset:13120
    ds_read_u16 v70, v7 offset:13632
    ds_read_u16 v71, v7 offset:14144
    s_waitcnt lgkmcnt(0)
    v_lshl_or_b32 v184, v65, 16, v64
    v_lshl_or_b32 v185, v67, 16, v66
    v_lshl_or_b32 v186, v69, 16, v68
    v_lshl_or_b32 v187, v71, 16, v70
    ds_read_u16 v64, v7 offset:12576
    ds_read_u16 v65, v7 offset:13088
    ds_read_u16 v66, v7 offset:13600
    ds_read_u16 v67, v7 offset:14112
    ds_read_u16 v68, v7 offset:12640
    ds_read_u16 v69, v7 offset:13152
    ds_read_u16 v70, v7 offset:13664
    ds_read_u16 v71, v7 offset:14176
    s_waitcnt lgkmcnt(0)
    v_lshl_or_b32 v188, v65, 16, v64
    v_lshl_or_b32 v189, v67, 16, v66
    v_lshl_or_b32 v190, v69, 16, v68
    v_lshl_or_b32 v191, v71, 16, v70
    s_branch L_ste
L_st3:
    s_waitcnt vmcnt(15)
    ds_write_b128 v3, v[64:67] offset:0
    s_waitcnt vmcnt(14)
    ds_write_b128 v3, v[68:71] offset:1024
    s_waitcnt vmcnt(13)
    ds_write_b128 v3, v[72:75] offset:2048
    s_waitcnt vmcnt(12)
    ds_write_b128 v3, v[76:79] offset:3072
    s_waitcnt vmcnt(11)
    ds_write_b128 v3, v[80:83] offset:4096
    s_waitcnt vmcnt(10)
    ds_write_b128 v3, v[84:87] offset:5120
    s_waitcnt vmcnt(9)
    ds_write_b128 v3, v[88:91] offset:6144
    s_waitcnt vmcnt(8)
    ds_write_b128 v3, v[92:95] offset:7168
    s_waitcnt vmcnt(7)
    ds_write_b128 v3, v[96:99] offset:8192
    s_waitcnt vmcnt(6)
    ds_write_b128 v3, v[100:103] offset:9216
    s_waitcnt vmcnt(5)
    ds_write_b128 v3, v[104:107] offset:10240
    s_waitcnt vmcnt(4)
    ds_write_b128 v3, v[108:111] offset:11264
    s_waitcnt vmcnt(3)
    ds_write_b128 v3, v[112:115] offset:12288
    s_waitcnt vmcnt(2)
    ds_write_b128 v3, v[116:119] offset:13312
    s_waitcnt vmcnt(1)
    ds_write_b128 v3, v[120:123] offset:14336
    s_waitcnt vmcnt(0)
    ds_write_b128 v3, v[124:127] offset:15360
    s_waitcnt lgkmcnt(0)
    v_lshlrev_b32 v7, 2, v0
    global_load_dword v40, v7, s[4:5]
    v_and_b32 v7, 31, v1
    v_lshlrev_b32 v7, 1, v7
    s_lshl_b32 s75, s73, 6
    v_add_u32 v7, s75, v7
    global_load_ushort v41, v7, s[18:19]
    v_lshlrev_b32 v7, 9, v5
    v_lshl_add_u32 v7, v6, 1, v7
    v_add_u32 v7, s74, v7
    v_lshlrev_b32 v8, 11, v5
    v_lshl_add_u32 v8, v6, 1, v8
    v_add_u32 v8, s74, v8
    ds_read_u16 v64, v7 offset:0
    ds_read_u16 v65, v7 offset:64
    ds_read_u16 v66, v7 offset:128
    ds_read_u16 v67, v7 offset:192
    ds_read_u16 v68, v7 offset:256
    ds_read_u16 v69, v7 offset:320
    ds_read_u16 v70, v7 offset:384
    ds_read_u16 v71, v7 offset:448
    s_waitcnt lgkmcnt(0)
    v_lshl_or_b32 v128, v65, 16, v64
    v_lshl_or_b32 v129, v67, 16, v66
    v_lshl_or_b32 v130, v69, 16, v68
    v_lshl_or_b32 v131, v71, 16, v70
    ds_read_u16 v64, v7 offset:32
    ds_read_u16 v65, v7 offset:96
    ds_read_u16 v66, v7 offset:160
    ds_read_u16 v67, v7 offset:224
    ds_read_u16 v68, v7 offset:288
    ds_read_u16 v69, v7 offset:352
    ds_read_u16 v70, v7 offset:416
    ds_read_u16 v71, v7 offset:480
    s_waitcnt lgkmcnt(0)
    v_lshl_or_b32 v132, v65, 16, v64
    v_lshl_or_b32 v133, v67, 16, v66
    v_lshl_or_b32 v134, v69, 16, v68
    v_lshl_or_b32 v135, v71, 16, v70
    ds_read_u16 v64, v7 offset:2048
    ds_read_u16 v65, v7 offset:2112
    ds_read_u16 v66, v7 offset:2176
    ds_read_u16 v67, v7 offset:2240
    ds_read_u16 v68, v7 offset:2304
    ds_read_u16 v69, v7 offset:2368
    ds_read_u16 v70, v7 offset:2432
    ds_read_u16 v71, v7 offset:2496
    s_waitcnt lgkmcnt(0)
    v_lshl_or_b32 v136, v65, 16, v64
    v_lshl_or_b32 v137, v67, 16, v66
    v_lshl_or_b32 v138, v69, 16, v68
    v_lshl_or_b32 v139, v71, 16, v70
    ds_read_u16 v64, v7 offset:2080
    ds_read_u16 v65, v7 offset:2144
    ds_read_u16 v66, v7 offset:2208
    ds_read_u16 v67, v7 offset:2272
    ds_read_u16 v68, v7 offset:2336
    ds_read_u16 v69, v7 offset:2400
    ds_read_u16 v70, v7 offset:2464
    ds_read_u16 v71, v7 offset:2528
    s_waitcnt lgkmcnt(0)
    v_lshl_or_b32 v140, v65, 16, v64
    v_lshl_or_b32 v141, v67, 16, v66
    v_lshl_or_b32 v142, v69, 16, v68
    v_lshl_or_b32 v143, v71, 16, v70
    ds_read_u16 v64, v7 offset:4096
    ds_read_u16 v65, v7 offset:4160
    ds_read_u16 v66, v7 offset:4224
    ds_read_u16 v67, v7 offset:4288
    ds_read_u16 v68, v7 offset:4352
    ds_read_u16 v69, v7 offset:4416
    ds_read_u16 v70, v7 offset:4480
    ds_read_u16 v71, v7 offset:4544
    s_waitcnt lgkmcnt(0)
    v_lshl_or_b32 v144, v65, 16, v64
    v_lshl_or_b32 v145, v67, 16, v66
    v_lshl_or_b32 v146, v69, 16, v68
    v_lshl_or_b32 v147, v71, 16, v70
    ds_read_u16 v64, v7 offset:4128
    ds_read_u16 v65, v7 offset:4192
    ds_read_u16 v66, v7 offset:4256
    ds_read_u16 v67, v7 offset:4320
    ds_read_u16 v68, v7 offset:4384
    ds_read_u16 v69, v7 offset:4448
    ds_read_u16 v70, v7 offset:4512
    ds_read_u16 v71, v7 offset:4576
    s_waitcnt lgkmcnt(0)
    v_lshl_or_b32 v148, v65, 16, v64
    v_lshl_or_b32 v149, v67, 16, v66
    v_lshl_or_b32 v150, v69, 16, v68
    v_lshl_or_b32 v151, v71, 16, v70
    ds_read_u16 v64, v7 offset:6144
    ds_read_u16 v65, v7 offset:6208
    ds_read_u16 v66, v7 offset:6272
    ds_read_u16 v67, v7 offset:6336
    ds_read_u16 v68, v7 offset:6400
    ds_read_u16 v69, v7 offset:6464
    ds_read_u16 v70, v7 offset:6528
    ds_read_u16 v71, v7 offset:6592
    s_waitcnt lgkmcnt(0)
    v_lshl_or_b32 v152, v65, 16, v64
    v_lshl_or_b32 v153, v67, 16, v66
    v_lshl_or_b32 v154, v69, 16, v68
    v_lshl_or_b32 v155, v71, 16, v70
    ds_read_u16 v64, v7 offset:6176
    ds_read_u16 v65, v7 offset:6240
    ds_read_u16 v66, v7 offset:6304
    ds_read_u16 v67, v7 offset:6368
    ds_read_u16 v68, v7 offset:6432
    ds_read_u16 v69, v7 offset:6496
    ds_read_u16 v70, v7 offset:6560
    ds_read_u16 v71, v7 offset:6624
    s_waitcnt lgkmcnt(0)
    v_lshl_or_b32 v156, v65, 16, v64
    v_lshl_or_b32 v157, v67, 16, v66
    v_lshl_or_b32 v158, v69, 16, v68
    v_lshl_or_b32 v159, v71, 16, v70
    ds_read_u16 v64, v8 offset:8192
    ds_read_u16 v65, v8 offset:8448
    ds_read_u16 v66, v8 offset:8704
    ds_read_u16 v67, v8 offset:8960
    ds_read_u16 v68, v8 offset:9216
    ds_read_u16 v69, v8 offset:9472
    ds_read_u16 v70, v8 offset:9728
    ds_read_u16 v71, v8 offset:9984
    s_waitcnt lgkmcnt(0)
    v_lshl_or_b32 v160, v65, 16, v64
    v_lshl_or_b32 v161, v67, 16, v66
    v_lshl_or_b32 v162, v69, 16, v68
    v_lshl_or_b32 v163, v71, 16, v70
    ds_read_u16 v64, v8 offset:8224
    ds_read_u16 v65, v8 offset:8480
    ds_read_u16 v66, v8 offset:8736
    ds_read_u16 v67, v8 offset:8992
    ds_read_u16 v68, v8 offset:9248
    ds_read_u16 v69, v8 offset:9504
    ds_read_u16 v70, v8 offset:9760
    ds_read_u16 v71, v8 offset:10016
    s_waitcnt lgkmcnt(0)
    v_lshl_or_b32 v164, v65, 16, v64
    v_lshl_or_b32 v165, v67, 16, v66
    v_lshl_or_b32 v166, v69, 16, v68
    v_lshl_or_b32 v167, v71, 16, v70
    ds_read_u16 v64, v8 offset:8256
    ds_read_u16 v65, v8 offset:8512
    ds_read_u16 v66, v8 offset:8768
    ds_read_u16 v67, v8 offset:9024
    ds_read_u16 v68, v8 offset:9280
    ds_read_u16 v69, v8 offset:9536
    ds_read_u16 v70, v8 offset:9792
    ds_read_u16 v71, v8 offset:10048
    s_waitcnt lgkmcnt(0)
    v_lshl_or_b32 v168, v65, 16, v64
    v_lshl_or_b32 v169, v67, 16, v66
    v_lshl_or_b32 v170, v69, 16, v68
    v_lshl_or_b32 v171, v71, 16, v70
    ds_read_u16 v64, v8 offset:8288
    ds_read_u16 v65, v8 offset:8544
    ds_read_u16 v66, v8 offset:8800
    ds_read_u16 v67, v8 offset:9056
    ds_read_u16 v68, v8 offset:9312
    ds_read_u16 v69, v8 offset:9568
    ds_read_u16 v70, v8 offset:9824
    ds_read_u16 v71, v8 offset:10080
    s_waitcnt lgkmcnt(0)
    v_lshl_or_b32 v172, v65, 16, v64
    v_lshl_or_b32 v173, v67, 16, v66
    v_lshl_or_b32 v174, v69, 16, v68
    v_lshl_or_b32 v175, v71, 16, v70
    ds_read_u16 v64, v8 offset:8320
    ds_read_u16 v65, v8 offset:8576
    ds_read_u16 v66, v8 offset:8832
    ds_read_u16 v67, v8 offset:9088
    ds_read_u16 v68, v8 offset:9344
    ds_read_u16 v69, v8 offset:9600
    ds_read_u16 v70, v8 offset:9856
    ds_read_u16 v71, v8 offset:10112
    s_waitcnt lgkmcnt(0)
    v_lshl_or_b32 v176, v65, 16, v64
    v_lshl_or_b32 v177, v67, 16, v66
    v_lshl_or_b32 v178, v69, 16, v68
    v_lshl_or_b32 v179, v71, 16, v70
    ds_read_u16 v64, v8 offset:8352
    ds_read_u16 v65, v8 offset:8608
    ds_read_u16 v66, v8 offset:8864
    ds_read_u16 v67, v8 offset:9120
    ds_read_u16 v68, v8 offset:9376
    ds_read_u16 v69, v8 offset:9632
    ds_read_u16 v70, v8 offset:9888
    ds_read_u16 v71, v8 offset:10144
    s_waitcnt lgkmcnt(0)
    v_lshl_or_b32 v180, v65, 16, v64
    v_lshl_or_b32 v181, v67, 16, v66
    v_lshl_or_b32 v182, v69, 16, v68
    v_lshl_or_b32 v183, v71, 16, v70
    ds_read_u16 v64, v8 offset:8384
    ds_read_u16 v65, v8 offset:8640
    ds_read_u16 v66, v8 offset:8896
    ds_read_u16 v67, v8 offset:9152
    ds_read_u16 v68, v8 offset:9408
    ds_read_u16 v69, v8 offset:9664
    ds_read_u16 v70, v8 offset:9920
    ds_read_u16 v71, v8 offset:10176
    s_waitcnt lgkmcnt(0)
    v_lshl_or_b32 v184, v65, 16, v64
    v_lshl_or_b32 v185, v67, 16, v66
    v_lshl_or_b32 v186, v69, 16, v68
    v_lshl_or_b32 v187, v71, 16, v70
    ds_read_u16 v64, v8 offset:8416
    ds_read_u16 v65, v8 offset:8672
    ds_read_u16 v66, v8 offset:8928
    ds_read_u16 v67, v8 offset:9184
    ds_read_u16 v68, v8 offset:9440
    ds_read_u16 v69, v8 offset:9696
    ds_read_u16 v70, v8 offset:9952
    ds_read_u16 v71, v8 offset:10208
    s_waitcnt lgkmcnt(0)
    v_lshl_or_b32 v188, v65, 16, v64
    v_lshl_or_b32 v189, v67, 16, v66
    v_lshl_or_b32 v190, v69, 16, v68
    v_lshl_or_b32 v191, v71, 16, v70
L_ste:
    v_lshlrev_b32 v10, 6, v0
    s_mov_b32 s74, 0x0
    s_mov_b32 s79, 65536
L_pa:
    buffer_load_dword v13, v10, s[40:43], s74 offen offset:4 sc1
    s_waitcnt vmcnt(0)
    v_cmp_ne_u32 vcc, s63, v13
    s_cbranch_vccz L_pa_ok
    s_sub_u32 s79, s79, 1
    s_cmp_lg_u32 s79, 0
    s_cbranch_scc1 L_pa
L_pa_ok:
L_rdy:
    s_mov_b32 s78, 65536
L_tail:
    s_lshl_b32 s74, s60, 3
    v_mov_b32 v7, s74
    s_lshl_b32 s74, s60, 9
    v_add_u32 v8, s74, v2
    s_lshl_b32 s75, s2, 11
    s_add_u32 s75, s75, s74
    s_add_u32 s75, s75, 0x40000
    s_lshl_b32 s76, s61, 2
    s_add_u32 s76, s76, s60
    s_lshl_b32 s76, s76, 8
    s_and_b32 s77, s62, 3
    s_lshl_b32 s77, s77, 6
    s_add_u32 s76, s76, s77
    s_lshr_b32 s77, s62, 2
    s_lshl_b32 s77, s77, 3
    s_add_u32 s76, s76, s77
    s_add_u32 s76, s76, 0x4000
    s_barrier
    ds_read_b64 v[16:17], v7 offset:9216
    ds_read_b64 v[18:19], v7 offset:9248
    ds_read_b64 v[20:21], v7 offset:9280
    ds_read_b64 v[22:23], v7 offset:9312
    ds_read_b128 v[64:67], v8 offset:1024
    ds_read_b128 v[68:71], v8 offset:3072
    ds_read_b128 v[72:75], v8 offset:5120
    ds_read_b128 v[76:79], v8 offset:7168
    s_waitcnt lgkmcnt(4)
    v_max3_f32 v32, v16, v18, v20
    v_max_f32 v32, v32, v22
    v_sub_f32 v16, v16, v32
    v_sub_f32 v18, v18, v32
    v_sub_f32 v20, v20, v32
    v_sub_f32 v22, v22, v32
    v_exp_f32 v16, v16
    v_exp_f32 v18, v18
    v_exp_f32 v20, v20
    v_exp_f32 v22, v22
    s_waitcnt lgkmcnt(0)
    v_pk_mul_f32 v[36:37], v[64:65], v[16:17] op_sel_hi:[1,0]
    v_pk_mul_f32 v[38:39], v[66:67], v[16:17] op_sel_hi:[1,0]
    v_pk_fma_f32 v[36:37], v[68:69], v[18:19], v[36:37] op_sel_hi:[1,0,1]
    v_pk_fma_f32 v[38:39], v[70:71], v[18:19], v[38:39] op_sel_hi:[1,0,1]
    v_pk_fma_f32 v[36:37], v[72:73], v[20:21], v[36:37] op_sel_hi:[1,0,1]
    v_pk_fma_f32 v[38:39], v[74:75], v[20:21], v[38:39] op_sel_hi:[1,0,1]
    v_pk_fma_f32 v[36:37], v[76:77], v[22:23], v[36:37] op_sel_hi:[1,0,1]
    v_pk_fma_f32 v[38:39], v[78:79], v[22:23], v[38:39] op_sel_hi:[1,0,1]
    s_mov_b32 exec_hi, 0
    buffer_store_dwordx4 v[36:39], v2, s[40:43], s75 offen sc1
    v_mul_f32 v33, v16, v17
    v_fmac_f32 v33, v18, v19
    v_fmac_f32 v33, v20, v21
    v_fmac_f32 v33, v22, v23
    s_mov_b64 exec, 1
    buffer_store_dwordx2 v[32:33], off, s[40:43], s76 sc1
    s_mov_b64 exec, -1
    s_cmp_eq_u32 s72, 2
    s_cbranch_scc1 L_s2
    s_cmp_eq_u32 s72, 3
    s_cbranch_scc1 L_s3
    s_cmp_eq_u32 s72, 4
    s_cbranch_scc1 L_s4
    s_branch L_fin
L_s2:
    s_lshr_b32 s74, s73, 2
    s_lshl_b32 s75, s74, 1
    s_lshr_b32 s76, s60, 1
    s_add_u32 s75, s75, s76
    s_lshr_b32 s76, s75, 2
    s_lshl_b32 s76, s76, 16
    s_and_b32 s77, s75, 3
    s_lshl_b32 s77, s77, 9
    s_add_u32 s76, s76, s77
    s_and_b32 s77, s60, 1
    s_lshl_b32 s77, s77, 8
    s_add_u32 s76, s76, s77
    s_add_u32 s64, s76, 0x40000
    s_lshl_b32 s75, s75, 8
    s_add_u32 s75, s75, 0x4000
    v_lshlrev_b32 v7, 11, v5
    v_lshl_add_u32 v7, v6, 4, v7
    v_lshlrev_b32 v8, 6, v5
    s_add_u32 s65, s64, 8192
    s_add_u32 s66, s64, 16384
    s_add_u32 s67, s64, 24576
    s_add_u32 s68, s64, 32768
    s_add_u32 s69, s64, 40960
    s_add_u32 s70, s64, 49152
    s_add_u32 s71, s64, 57344
    v_mov_b32 v48, -1
    v_mov_b32 v49, -1
    v_mov_b32 v50, -1
    v_mov_b32 v51, -1
    v_mov_b32 v52, -1
    v_mov_b32 v53, -1
    v_mov_b32 v54, -1
    v_mov_b32 v55, -1
    v_mov_b32 v56, -1
    v_mov_b32 v57, -1
    v_mov_b32 v58, -1
    v_mov_b32 v59, -1
    s_mov_b32 s79, 65536
L_p2:
    v_cmpx_eq_u32 vcc, -1, v48
    buffer_load_dwordx4 v[64:67], v7, s[40:43], s64 offen sc1
    s_mov_b64 exec, -1
    v_cmpx_eq_u32 vcc, -1, v49
    buffer_load_dwordx4 v[68:71], v7, s[40:43], s65 offen sc1
    s_mov_b64 exec, -1
    v_cmpx_eq_u32 vcc, -1, v50
    buffer_load_dwordx4 v[72:75], v7, s[40:43], s66 offen sc1
    s_mov_b64 exec, -1
    v_cmpx_eq_u32 vcc, -1, v51
    buffer_load_dwordx4 v[76:79], v7, s[40:43], s67 offen sc1
    s_mov_b64 exec, -1
    v_cmpx_eq_u32 vcc, -1, v52
    buffer_load_dwordx4 v[80:83], v7, s[40:43], s68 offen sc1
    s_mov_b64 exec, -1
    v_cmpx_eq_u32 vcc, -1, v53
    buffer_load_dwordx4 v[84:87], v7, s[40:43], s69 offen sc1
    s_mov_b64 exec, -1
    v_cmpx_eq_u32 vcc, -1, v54
    buffer_load_dwordx4 v[88:91], v7, s[40:43], s70 offen sc1
    s_mov_b64 exec, -1
    v_cmpx_eq_u32 vcc, -1, v55
    buffer_load_dwordx4 v[92:95], v7, s[40:43], s71 offen sc1
    s_mov_b64 exec, -1
    v_cmpx_eq_u32 vcc, -1, v56
    buffer_load_dwordx4 v[16:19], v8, s[40:43], s75 offen offset:0 sc1
    s_mov_b64 exec, -1
    v_cmpx_eq_u32 vcc, -1, v57
    buffer_load_dwordx4 v[20:23], v8, s[40:43], s75 offen offset:16 sc1
    s_mov_b64 exec, -1
    v_cmpx_eq_u32 vcc, -1, v58
    buffer_load_dwordx4 v[24:27], v8, s[40:43], s75 offen offset:32 sc1
    s_mov_b64 exec, -1
    v_cmpx_eq_u32 vcc, -1, v59
    buffer_load_dwordx4 v[28:31], v8, s[40:43], s75 offen offset:48 sc1
    s_mov_b64 exec, -1
    s_waitcnt vmcnt(0)
    v_max3_u32 v48, v64, v65, v66
    v_max3_u32 v49, v68, v69, v70
    v_max3_u32 v50, v72, v73, v74
    v_max3_u32 v51, v76, v77, v78
    v_max3_u32 v52, v80, v81, v82
    v_max3_u32 v53, v84, v85, v86
    v_max3_u32 v54, v88, v89, v90
    v_max3_u32 v55, v92, v93, v94
    v_max3_u32 v56, v16, v17, v18
    v_max3_u32 v57, v20, v21, v22
    v_max3_u32 v58, v24, v25, v26
    v_max3_u32 v59, v28, v29, v30
    v_max_u32 v48, v48, v67
    v_max_u32 v49, v49, v71
    v_max_u32 v50, v50, v75
    v_max_u32 v51, v51, v79
    v_max_u32 v52, v52, v83
    v_max_u32 v53, v53, v87
    v_max_u32 v54, v54, v91
    v_max_u32 v55, v55, v95
    v_max_u32 v56, v56, v19
    v_max_u32 v57, v57, v23
    v_max_u32 v58, v58, v27
    v_max_u32 v59, v59, v31
    v_max3_u32 v10, v48, v49, v50
    v_max3_u32 v10, v10, v51, v52
    v_max3_u32 v10, v10, v53, v54
    v_max3_u32 v10, v10, v55, v56
    v_max3_u32 v10, v10, v57, v58
    v_max_u32 v10, v10, v59
    v_cmp_eq_u32 vcc, -1, v10
    s_cbranch_vccz L_p2_ok
    s_sub_u32 s79, s79, 1
    s_cmp_lg_u32 s79, 0
    s_cbranch_scc1 L_p2
L_p2_ok:
    v_max3_f32 v32, v16, v18, v20
    v_max3_f32 v32, v32, v22, v24
    v_max3_f32 v32, v32, v26, v28
    v_max_f32 v32, v32, v30
    v_mov_b32 v33, v32
    s_nop 1
    v_permlane16_swap_b32 v33, v32
    v_max_f32 v32, v32, v33
    v_mov_b32 v33, v32
    s_nop 1
    v_permlane32_swap_b32 v33, v32
    v_max_f32 v32, v32, v33
    v_sub_f32 v16, v16, v32
    v_sub_f32 v18, v18, v32
    v_sub_f32 v20, v20, v32
    v_sub_f32 v22, v22, v32
    v_sub_f32 v24, v24, v32
    v_sub_f32 v26, v26, v32
    v_sub_f32 v28, v28, v32
    v_sub_f32 v30, v30, v32
    v_exp_f32 v16, v16
    v_exp_f32 v18, v18
    v_exp_f32 v20, v20
    v_exp_f32 v22, v22
    v_exp_f32 v24, v24
    v_exp_f32 v26, v26
    v_exp_f32 v28, v28
    v_exp_f32 v30, v30
    v_mul_f32 v33, v16, v17
    v_fmac_f32 v33, v18, v19
    v_fmac_f32 v33, v20, v21
    v_fmac_f32 v33, v22, v23
    v_fmac_f32 v33, v24, v25
    v_fmac_f32 v33, v26, v27
    v_fmac_f32 v33, v28, v29
    v_fmac_f32 v33, v30, v31
    v_pk_mul_f32 v[36:37], v[64:65], v[16:17] op_sel_hi:[1,0]
    v_pk_mul_f32 v[38:39], v[66:67], v[16:17] op_sel_hi:[1,0]
    v_mov_b32 v34, v33
    s_nop 1
    v_permlane16_swap_b32 v34, v33
    v_add_f32 v33, v33, v34
    v_mov_b32 v34, v33
    s_nop 1
    v_permlane32_swap_b32 v34, v33
    v_add_f32 v33, v33, v34
    v_pk_fma_f32 v[36:37], v[68:69], v[18:19], v[36:37] op_sel_hi:[1,0,1]
    v_pk_fma_f32 v[38:39], v[70:71], v[18:19], v[38:39] op_sel_hi:[1,0,1]
    v_pk_fma_f32 v[36:37], v[72:73], v[20:21], v[36:37] op_sel_hi:[1,0,1]
    v_pk_fma_f32 v[38:39], v[74:75], v[20:21], v[38:39] op_sel_hi:[1,0,1]
    v_pk_fma_f32 v[36:37], v[76:77], v[22:23], v[36:37] op_sel_hi:[1,0,1]
    v_pk_fma_f32 v[38:39], v[78:79], v[22:23], v[38:39] op_sel_hi:[1,0,1]
    v_pk_fma_f32 v[36:37], v[80:81], v[24:25], v[36:37] op_sel_hi:[1,0,1]
    v_pk_fma_f32 v[38:39], v[82:83], v[24:25], v[38:39] op_sel_hi:[1,0,1]
    v_pk_fma_f32 v[36:37], v[84:85], v[26:27], v[36:37] op_sel_hi:[1,0,1]
    v_pk_fma_f32 v[38:39], v[86:87], v[26:27], v[38:39] op_sel_hi:[1,0,1]
    v_pk_fma_f32 v[36:37], v[88:89], v[28:29], v[36:37] op_sel_hi:[1,0,1]
    v_pk_fma_f32 v[38:39], v[90:91], v[28:29], v[38:39] op_sel_hi:[1,0,1]
    v_pk_fma_f32 v[36:37], v[92:93], v[30:31], v[36:37] op_sel_hi:[1,0,1]
    v_pk_fma_f32 v[38:39], v[94:95], v[30:31], v[38:39] op_sel_hi:[1,0,1]
    v_rcp_f32 v33, v33
    s_lshl_b32 s76, s60, 7
    v_lshlrev_b32 v9, 3, v6
    v_lshl_add_u32 v9, v5, 1, v9
    v_add_u32 v9, s76, v9
    v_permlane16_swap_b32 v36, v37
    v_permlane16_swap_b32 v38, v39
    v_add_f32 v36, v36, v37
    v_add_f32 v38, v38, v39
    s_nop 1
    v_permlane32_swap_b32 v36, v38
    v_add_f32 v36, v36, v38
    v_mul_f32 v36, v36, v33
    v_cvt_pk_bf16_f32 v36, v36, v36
    ds_write_b16 v9, v36 offset:9472
    v_lshlrev_b32 v9, 4, v5
    s_waitcnt lgkmcnt(0)
    s_barrier
    ds_read_b128 v[64:67], v9 offset:9472
    ds_read_b128 v[68:71], v9 offset:9536
    ds_read_b128 v[72:75], v9 offset:9600
    ds_read_b128 v[76:79], v9 offset:9664
    ds_read_b128 v[80:83], v9 offset:9728
    ds_read_b128 v[84:87], v9 offset:9792
    ds_read_b128 v[88:91], v9 offset:9856
    ds_read_b128 v[92:95], v9 offset:9920
    s_lshl_b32 s76, s73, 9
    s_lshl_b32 s77, s60, 7
    s_add_u32 s76, s76, s77
    s_add_u32 s76, s76, 0x8000
    s_waitcnt lgkmcnt(7)
    v_mfma_f32_16x16x32_bf16 v[16:19], v[128:131], v[64:67], 0
    v_mfma_f32_16x16x32_bf16 v[20:23], v[132:135], v[64:67], 0
    s_waitcnt lgkmcnt(6)
    v_mfma_f32_16x16x32_bf16 v[16:19], v[136:139], v[68:71], v[16:19]
    v_mfma_f32_16x16x32_bf16 v[20:23], v[140:143], v[68:71], v[20:23]
    s_waitcnt lgkmcnt(5)
    v_mfma_f32_16x16x32_bf16 v[16:19], v[144:147], v[72:75], v[16:19]
    v_mfma_f32_16x16x32_bf16 v[20:23], v[148:151], v[72:75], v[20:23]
    s_waitcnt lgkmcnt(4)
    v_mfma_f32_16x16x32_bf16 v[16:19], v[152:155], v[76:79], v[16:19]
    v_mfma_f32_16x16x32_bf16 v[20:23], v[156:159], v[76:79], v[20:23]
    s_waitcnt lgkmcnt(3)
    v_mfma_f32_16x16x32_bf16 v[16:19], v[160:163], v[80:83], v[16:19]
    v_mfma_f32_16x16x32_bf16 v[20:23], v[164:167], v[80:83], v[20:23]
    s_waitcnt lgkmcnt(2)
    v_mfma_f32_16x16x32_bf16 v[16:19], v[168:171], v[84:87], v[16:19]
    v_mfma_f32_16x16x32_bf16 v[20:23], v[172:175], v[84:87], v[20:23]
    s_waitcnt lgkmcnt(1)
    v_mfma_f32_16x16x32_bf16 v[16:19], v[176:179], v[88:91], v[16:19]
    v_mfma_f32_16x16x32_bf16 v[20:23], v[180:183], v[88:91], v[20:23]
    s_waitcnt lgkmcnt(0)
    v_mfma_f32_16x16x32_bf16 v[16:19], v[184:187], v[92:95], v[16:19]
    v_mfma_f32_16x16x32_bf16 v[20:23], v[188:191], v[92:95], v[20:23]
    s_mov_b32 exec_lo, 0x00010001
    s_mov_b32 exec_hi, 0x00010001
    s_nop 4
    buffer_store_dwordx4 v[16:19], v9, s[40:43], s76 offen sc1
    buffer_store_dwordx4 v[20:23], v9, s[40:43], s76 offen offset:64 sc1
    s_mov_b64 exec, -1
    s_branch L_fin
L_s3:
    v_lshlrev_b32 v7, 3, v0
    s_mov_b32 s64, 0x8000
    s_mov_b32 s65, 0x9000
    s_mov_b32 s66, 0xa000
    s_mov_b32 s67, 0xb000
    s_mov_b32 s68, 0xc000
    s_mov_b32 s69, 0xd000
    s_mov_b32 s70, 0xe000
    s_mov_b32 s71, 0xf000
    s_lshl_b32 s74, s60, 9
    v_lshl_add_u32 v9, v6, 11, s74
    s_mov_b32 s79, 65536
L_p3a:
    buffer_load_dword v10, v9, s[40:43], s64 offen sc1
    s_waitcnt vmcnt(0)
    v_cmp_ne_u32 vcc, -1, v10
    s_cbranch_vccnz L_p3b
    s_sub_u32 s79, s79, 1
    s_cmp_lg_u32 s79, 0
    s_cbranch_scc1 L_p3a
L_p3b:
    v_mov_b32 v16, -1
    v_mov_b32 v17, -1
    v_mov_b32 v18, -1
    v_mov_b32 v19, -1
    v_mov_b32 v20, -1
    v_mov_b32 v21, -1
    v_mov_b32 v22, -1
    v_mov_b32 v23, -1
    v_mov_b32 v24, -1
    v_mov_b32 v25, -1
    v_mov_b32 v26, -1
    v_mov_b32 v27, -1
    v_mov_b32 v28, -1
    v_mov_b32 v29, -1
    v_mov_b32 v30, -1
    v_mov_b32 v31, -1
    s_mov_b32 s79, 65536
L_p3:
    v_cmpx_eq_u32 vcc, -1, v16
    buffer_load_dwordx2 v[64:65], v7, s[40:43], s64 offen offset:0 sc1
    s_mov_b64 exec, -1
    v_cmpx_eq_u32 vcc, -1, v17
    buffer_load_dwordx2 v[66:67], v7, s[40:43], s64 offen offset:2048 sc1
    s_mov_b64 exec, -1
    v_cmpx_eq_u32 vcc, -1, v18
    buffer_load_dwordx2 v[68:69], v7, s[40:43], s65 offen offset:0 sc1
    s_mov_b64 exec, -1
    v_cmpx_eq_u32 vcc, -1, v19
    buffer_load_dwordx2 v[70:71], v7, s[40:43], s65 offen offset:2048 sc1
    s_mov_b64 exec, -1
    v_cmpx_eq_u32 vcc, -1, v20
    buffer_load_dwordx2 v[72:73], v7, s[40:43], s66 offen offset:0 sc1
    s_mov_b64 exec, -1
    v_cmpx_eq_u32 vcc, -1, v21
    buffer_load_dwordx2 v[74:75], v7, s[40:43], s66 offen offset:2048 sc1
    s_mov_b64 exec, -1
    v_cmpx_eq_u32 vcc, -1, v22
    buffer_load_dwordx2 v[76:77], v7, s[40:43], s67 offen offset:0 sc1
    s_mov_b64 exec, -1
    v_cmpx_eq_u32 vcc, -1, v23
    buffer_load_dwordx2 v[78:79], v7, s[40:43], s67 offen offset:2048 sc1
    s_mov_b64 exec, -1
    v_cmpx_eq_u32 vcc, -1, v24
    buffer_load_dwordx2 v[80:81], v7, s[40:43], s68 offen offset:0 sc1
    s_mov_b64 exec, -1
    v_cmpx_eq_u32 vcc, -1, v25
    buffer_load_dwordx2 v[82:83], v7, s[40:43], s68 offen offset:2048 sc1
    s_mov_b64 exec, -1
    v_cmpx_eq_u32 vcc, -1, v26
    buffer_load_dwordx2 v[84:85], v7, s[40:43], s69 offen offset:0 sc1
    s_mov_b64 exec, -1
    v_cmpx_eq_u32 vcc, -1, v27
    buffer_load_dwordx2 v[86:87], v7, s[40:43], s69 offen offset:2048 sc1
    s_mov_b64 exec, -1
    v_cmpx_eq_u32 vcc, -1, v28
    buffer_load_dwordx2 v[88:89], v7, s[40:43], s70 offen offset:0 sc1
    s_mov_b64 exec, -1
    v_cmpx_eq_u32 vcc, -1, v29
    buffer_load_dwordx2 v[90:91], v7, s[40:43], s70 offen offset:2048 sc1
    s_mov_b64 exec, -1
    v_cmpx_eq_u32 vcc, -1, v30
    buffer_load_dwordx2 v[92:93], v7, s[40:43], s71 offen offset:0 sc1
    s_mov_b64 exec, -1
    v_cmpx_eq_u32 vcc, -1, v31
    buffer_load_dwordx2 v[94:95], v7, s[40:43], s71 offen offset:2048 sc1
    s_mov_b64 exec, -1
    s_waitcnt vmcnt(0)
    v_max_u32 v16, v64, v65
    v_max_u32 v17, v66, v67
    v_max_u32 v18, v68, v69
    v_max_u32 v19, v70, v71
    v_max_u32 v20, v72, v73
    v_max_u32 v21, v74, v75
    v_max_u32 v22, v76, v77
    v_max_u32 v23, v78, v79
    v_max_u32 v24, v80, v81
    v_max_u32 v25, v82, v83
    v_max_u32 v26, v84, v85
    v_max_u32 v27, v86, v87
    v_max_u32 v28, v88, v89
    v_max_u32 v29, v90, v91
    v_max_u32 v30, v92, v93
    v_max_u32 v31, v94, v95
    v_max3_u32 v10, v16, v17, v18
    v_max3_u32 v10, v10, v19, v20
    v_max3_u32 v10, v10, v21, v22
    v_max3_u32 v10, v10, v23, v24
    v_max3_u32 v10, v10, v25, v26
    v_max3_u32 v10, v10, v27, v28
    v_max3_u32 v10, v10, v29, v30
    v_max_u32 v10, v10, v31
    v_cmp_eq_u32 vcc, -1, v10
    s_cbranch_vccz L_p3_ok
    s_sub_u32 s79, s79, 1
    s_cmp_lg_u32 s79, 0
    s_cbranch_scc1 L_p3
L_p3_ok:
    v_pk_add_f32 v[64:65], v[64:65], v[80:81]
    v_pk_add_f32 v[66:67], v[66:67], v[82:83]
    v_pk_add_f32 v[68:69], v[68:69], v[84:85]
    v_pk_add_f32 v[70:71], v[70:71], v[86:87]
    v_pk_add_f32 v[72:73], v[72:73], v[88:89]
    v_pk_add_f32 v[74:75], v[74:75], v[90:91]
    v_pk_add_f32 v[76:77], v[76:77], v[92:93]
    v_pk_add_f32 v[78:79], v[78:79], v[94:95]
    v_pk_add_f32 v[64:65], v[64:65], v[72:73]
    v_pk_add_f32 v[66:67], v[66:67], v[74:75]
    v_pk_add_f32 v[68:69], v[68:69], v[76:77]
    v_pk_add_f32 v[70:71], v[70:71], v[78:79]
    v_pk_add_f32 v[64:65], v[64:65], v[68:69]
    v_pk_add_f32 v[66:67], v[66:67], v[70:71]
    v_pk_add_f32 v[64:65], v[64:65], v[66:67]
    v_lshlrev_b32 v42, 16, v40
    v_and_b32 v43, 0xffff0000, v40
    v_cvt_pk_bf16_f32 v64, 0, v64
    v_cvt_pk_bf16_f32 v65, 0, v65
    v_pk_add_f32 v[64:65], v[64:65], v[42:43]
    v_lshlrev_b32 v7, 2, v0
    v_cvt_pk_bf16_f32 v64, v64, v65
    ds_write_b32 v7, v64 offset:10240
    s_waitcnt lgkmcnt(0)
    s_barrier
    ds_read_b128 v[44:47], v2 offset:10240
    s_lshl_b32 s74, s60, 10
    v_add_u32 v7, s74, v2
    s_lshl_b32 s75, s60, 8
    s_add_u32 s75, s75, s74
    v_lshlrev_b32 v8, 4, v5
    v_add_u32 v8, s75, v8
    s_waitcnt lgkmcnt(0)
    v_lshlrev_b32 v16, 16, v44
    v_and_b32 v17, 0xffff0000, v44
    v_lshlrev_b32 v18, 16, v45
    v_and_b32 v19, 0xffff0000, v45
    v_lshlrev_b32 v20, 16, v46
    v_and_b32 v21, 0xffff0000, v46
    v_lshlrev_b32 v22, 16, v47
    v_and_b32 v23, 0xffff0000, v47
    v_pk_add_f32 v[24:25], v[16:17], v[18:19]
    v_pk_add_f32 v[26:27], v[20:21], v[22:23]
    v_pk_add_f32 v[24:25], v[24:25], v[26:27]
    v_add_f32 v24, v24, v25
    s_nop 1
    v_add_f32_dpp v24, v24, v24 row_ror:8 row_mask:0xf bank_mask:0xf
    s_nop 1
    v_add_f32_dpp v24, v24, v24 row_ror:4 row_mask:0xf bank_mask:0xf
    s_nop 1
    v_add_f32_dpp v24, v24, v24 row_ror:2 row_mask:0xf bank_mask:0xf
    s_nop 1
    v_add_f32_dpp v24, v24, v24 row_ror:1 row_mask:0xf bank_mask:0xf
    v_mov_b32 v25, v24
    s_nop 1
    v_permlane16_swap_b32 v25, v24
    v_add_f32 v24, v24, v25
    v_mov_b32 v25, v24
    s_nop 1
    v_permlane32_swap_b32 v25, v24
    v_add_f32 v24, v24, v25
    v_mul_f32 v24, 0x3b000000, v24
    v_pk_add_f32 v[28:29], v[16:17], v[24:25] op_sel_hi:[1,0] neg_lo:[0,1] neg_hi:[0,1]
    v_pk_add_f32 v[30:31], v[18:19], v[24:25] op_sel_hi:[1,0] neg_lo:[0,1] neg_hi:[0,1]
    v_pk_add_f32 v[32:33], v[20:21], v[24:25] op_sel_hi:[1,0] neg_lo:[0,1] neg_hi:[0,1]
    v_pk_add_f32 v[34:35], v[22:23], v[24:25] op_sel_hi:[1,0] neg_lo:[0,1] neg_hi:[0,1]
    v_pk_mul_f32 v[26:27], v[28:29], v[28:29]
    v_pk_fma_f32 v[26:27], v[30:31], v[30:31], v[26:27]
    v_pk_fma_f32 v[26:27], v[32:33], v[32:33], v[26:27]
    v_pk_fma_f32 v[26:27], v[34:35], v[34:35], v[26:27]
    v_add_f32 v26, v26, v27
    v_cvt_pk_bf16_f32 v24, 0, v24
    s_nop 0
    v_add_f32_dpp v26, v26, v26 row_ror:8 row_mask:0xf bank_mask:0xf
    s_nop 1
    v_add_f32_dpp v26, v26, v26 row_ror:4 row_mask:0xf bank_mask:0xf
    s_nop 1
    v_add_f32_dpp v26, v26, v26 row_ror:2 row_mask:0xf bank_mask:0xf
    s_nop 1
    v_add_f32_dpp v26, v26, v26 row_ror:1 row_mask:0xf bank_mask:0xf
    v_mov_b32 v27, v26
    s_nop 1
    v_permlane16_swap_b32 v27, v26
    v_add_f32 v26, v26, v27
    v_mov_b32 v27, v26
    s_nop 1
    v_permlane32_swap_b32 v27, v26
    v_add_f32 v26, v26, v27
    v_pk_add_f32 v[16:17], v[16:17], v[24:25] op_sel_hi:[1,0] neg_lo:[0,1] neg_hi:[0,1]
    v_pk_add_f32 v[18:19], v[18:19], v[24:25] op_sel_hi:[1,0] neg_lo:[0,1] neg_hi:[0,1]
    v_pk_add_f32 v[20:21], v[20:21], v[24:25] op_sel_hi:[1,0] neg_lo:[0,1] neg_hi:[0,1]
    v_pk_add_f32 v[22:23], v[22:23], v[24:25] op_sel_hi:[1,0] neg_lo:[0,1] neg_hi:[0,1]
    v_mul_f32 v26, 0x3b000000, v26
    v_cvt_pk_bf16_f32 v26, 0, v26
    v_add_f32 v26, 0x3727c5ac, v26
    v_cvt_pk_bf16_f32 v26, 0, v26
    v_sqrt_f32 v26, v26
    v_cvt_pk_bf16_f32 v16, 0, v16
    v_cvt_pk_bf16_f32 v17, 0, v17
    v_cvt_pk_bf16_f32 v18, 0, v18
    v_cvt_pk_bf16_f32 v19, 0, v19
    v_cvt_pk_bf16_f32 v26, 0, v26
    v_rcp_f32 v26, v26
    v_cvt_pk_bf16_f32 v20, 0, v20
    v_cvt_pk_bf16_f32 v21, 0, v21
    v_cvt_pk_bf16_f32 v22, 0, v22
    v_cvt_pk_bf16_f32 v23, 0, v23
    v_pk_mul_f32 v[16:17], v[16:17], v[26:27] op_sel_hi:[1,0]
    v_pk_mul_f32 v[18:19], v[18:19], v[26:27] op_sel_hi:[1,0]
    v_pk_mul_f32 v[20:21], v[20:21], v[26:27] op_sel_hi:[1,0]
    v_pk_mul_f32 v[22:23], v[22:23], v[26:27] op_sel_hi:[1,0]
    v_cvt_pk_bf16_f32 v16, 0, v16
    v_cvt_pk_bf16_f32 v17, 0, v17
    v_cvt_pk_bf16_f32 v18, 0, v18
    v_cvt_pk_bf16_f32 v19, 0, v19
    v_cvt_pk_bf16_f32 v20, 0, v20
    v_cvt_pk_bf16_f32 v21, 0, v21
    v_cvt_pk_bf16_f32 v22, 0, v22
    v_cvt_pk_bf16_f32 v23, 0, v23
    v_pk_add_f32 v[24:25], v[16:17], v[18:19]
    v_pk_add_f32 v[26:27], v[20:21], v[22:23]
    v_pk_add_f32 v[24:25], v[24:25], v[26:27]
    v_add_f32 v24, v24, v25
    s_nop 1
    v_add_f32_dpp v24, v24, v24 row_ror:8 row_mask:0xf bank_mask:0xf
    s_nop 1
    v_add_f32_dpp v24, v24, v24 row_ror:4 row_mask:0xf bank_mask:0xf
    s_nop 1
    v_add_f32_dpp v24, v24, v24 row_ror:2 row_mask:0xf bank_mask:0xf
    s_nop 1
    v_add_f32_dpp v24, v24, v24 row_ror:1 row_mask:0xf bank_mask:0xf
    v_mov_b32 v25, v24
    s_nop 1
    v_permlane16_swap_b32 v25, v24
    v_add_f32 v24, v24, v25
    v_mov_b32 v25, v24
    s_nop 1
    v_permlane32_swap_b32 v25, v24
    v_add_f32 v24, v24, v25
    v_mul_f32 v24, 0x3b000000, v24
    v_pk_add_f32 v[28:29], v[16:17], v[24:25] op_sel_hi:[1,0] neg_lo:[0,1] neg_hi:[0,1]
    v_pk_add_f32 v[30:31], v[18:19], v[24:25] op_sel_hi:[1,0] neg_lo:[0,1] neg_hi:[0,1]
    v_pk_add_f32 v[32:33], v[20:21], v[24:25] op_sel_hi:[1,0] neg_lo:[0,1] neg_hi:[0,1]
    v_pk_add_f32 v[34:35], v[22:23], v[24:25] op_sel_hi:[1,0] neg_lo:[0,1] neg_hi:[0,1]
    v_pk_mul_f32 v[26:27], v[28:29], v[28:29]
    v_pk_fma_f32 v[26:27], v[30:31], v[30:31], v[26:27]
    v_pk_fma_f32 v[26:27], v[32:33], v[32:33], v[26:27]
    v_pk_fma_f32 v[26:27], v[34:35], v[34:35], v[26:27]
    v_add_f32 v26, v26, v27
    v_cvt_pk_bf16_f32 v24, 0, v24
    s_nop 0
    v_add_f32_dpp v26, v26, v26 row_ror:8 row_mask:0xf bank_mask:0xf
    s_nop 1
    v_add_f32_dpp v26, v26, v26 row_ror:4 row_mask:0xf bank_mask:0xf
    s_nop 1
    v_add_f32_dpp v26, v26, v26 row_ror:2 row_mask:0xf bank_mask:0xf
    s_nop 1
    v_add_f32_dpp v26, v26, v26 row_ror:1 row_mask:0xf bank_mask:0xf
    v_mov_b32 v27, v26
    s_nop 1
    v_permlane16_swap_b32 v27, v26
    v_add_f32 v26, v26, v27
    v_mov_b32 v27, v26
    s_nop 1
    v_permlane32_swap_b32 v27, v26
    v_add_f32 v26, v26, v27
    v_pk_add_f32 v[16:17], v[16:17], v[24:25] op_sel_hi:[1,0] neg_lo:[0,1] neg_hi:[0,1]
    v_pk_add_f32 v[18:19], v[18:19], v[24:25] op_sel_hi:[1,0] neg_lo:[0,1] neg_hi:[0,1]
    v_pk_add_f32 v[20:21], v[20:21], v[24:25] op_sel_hi:[1,0] neg_lo:[0,1] neg_hi:[0,1]
    v_pk_add_f32 v[22:23], v[22:23], v[24:25] op_sel_hi:[1,0] neg_lo:[0,1] neg_hi:[0,1]
    v_mul_f32 v26, 0x3b000000, v26
    v_cvt_pk_bf16_f32 v26, 0, v26
    v_add_f32 v26, 0x3727c5ac, v26
    v_cvt_pk_bf16_f32 v26, 0, v26
    v_sqrt_f32 v26, v26
    v_cvt_pk_bf16_f32 v16, 0, v16
    v_cvt_pk_bf16_f32 v17, 0, v17
    v_cvt_pk_bf16_f32 v18, 0, v18
    v_cvt_pk_bf16_f32 v19, 0, v19
    v_cvt_pk_bf16_f32 v26, 0, v26
    v_rcp_f32 v26, v26
    v_cvt_pk_bf16_f32 v20, 0, v20
    v_cvt_pk_bf16_f32 v21, 0, v21
    v_cvt_pk_bf16_f32 v22, 0, v22
    v_cvt_pk_bf16_f32 v23, 0, v23
    v_pk_mul_f32 v[16:17], v[16:17], v[26:27] op_sel_hi:[1,0]
    v_pk_mul_f32 v[18:19], v[18:19], v[26:27] op_sel_hi:[1,0]
    v_pk_mul_f32 v[20:21], v[20:21], v[26:27] op_sel_hi:[1,0]
    v_pk_mul_f32 v[22:23], v[22:23], v[26:27] op_sel_hi:[1,0]
    v_cvt_pk_bf16_f32 v44, v16, v17
    v_cvt_pk_bf16_f32 v45, v18, v19
    v_cvt_pk_bf16_f32 v46, v20, v21
    v_cvt_pk_bf16_f32 v47, v22, v23
    ds_write_b128 v7, v[44:47] offset:11264
    s_waitcnt lgkmcnt(0)
    ds_read_b128 v[64:67], v8 offset:11264
    ds_read_b128 v[68:71], v8 offset:11328
    ds_read_b128 v[72:75], v8 offset:11392
    ds_read_b128 v[76:79], v8 offset:11456
    s_lshl_b32 s74, s60, 7
    v_lshlrev_b32 v9, 2, v1
    v_add_u32 v9, s74, v9
    v_and_b32 v7, 31, v1
    v_lshlrev_b32 v8, 2, v7
    s_lshl_b32 s74, s60, 6
    v_lshl_add_u32 v7, v7, 1, s74
    v_lshl_add_u32 v11, v5, 4, s74
    v_lshlrev_b32 v48, 16, v41
    v_cmp_lt_u32 vcc, 15, v1
    s_waitcnt lgkmcnt(3)
    v_mfma_f32_16x16x32_bf16 v[16:19], v[64:67], v[128:131], 0
    v_mfma_f32_16x16x32_bf16 v[20:23], v[64:67], v[132:135], 0
    s_waitcnt lgkmcnt(2)
    v_mfma_f32_16x16x32_bf16 v[16:19], v[68:71], v[136:139], v[16:19]
    v_mfma_f32_16x16x32_bf16 v[20:23], v[68:71], v[140:143], v[20:23]
    s_waitcnt lgkmcnt(1)
    v_mfma_f32_16x16x32_bf16 v[16:19], v[72:75], v[144:147], v[16:19]
    v_mfma_f32_16x16x32_bf16 v[20:23], v[72:75], v[148:151], v[20:23]
    s_waitcnt lgkmcnt(0)
    v_mfma_f32_16x16x32_bf16 v[16:19], v[76:79], v[152:155], v[16:19]
    v_mfma_f32_16x16x32_bf16 v[20:23], v[76:79], v[156:159], v[20:23]
    s_nop 7
    v_cndmask_b32 v16, v16, v20, vcc
    s_mov_b32 exec_hi, 0
    ds_write_b32 v9, v16 offset:15360
    s_mov_b64 exec, -1
    s_waitcnt lgkmcnt(0)
    s_barrier
    ds_read_b32 v24, v8 offset:15360
    ds_read_b32 v25, v8 offset:15488
    ds_read_b32 v26, v8 offset:15616
    ds_read_b32 v27, v8 offset:15744
    s_waitcnt lgkmcnt(0)
    v_add_f32 v24, v24, v25
    v_add_f32 v26, v26, v27
    v_add_f32 v24, v24, v26
    v_cvt_pk_bf16_f32 v24, 0, v24
    v_add_f32 v24, v24, v48
    v_cvt_pk_bf16_f32 v24, 0, v24
    v_mul_f32 v25, v24, v24
    v_mul_f32 v25, 0x3d372713, v25
    v_fma_f32 v25, v25, v24, v24
    v_mul_f32 v25, 0xc0135761, v25
    v_exp_f32 v25, v25
    s_nop 0
    v_add_f32 v25, 1.0, v25
    v_rcp_f32 v25, v25
    s_nop 0
    v_mul_f32 v24, v24, v25
    v_cvt_pk_bf16_f32 v24, v24, v24
    ds_write_b16 v7, v24 offset:15872
    s_waitcnt lgkmcnt(0)
    ds_read_b128 v[28:31], v11 offset:15872
    s_lshl_b32 s74, s73, 11
    s_lshl_b32 s75, s60, 9
    s_add_u32 s74, s74, s75
    s_add_u32 s74, s74, 0x10000
    v_lshlrev_b32 v9, 4, v5
    s_waitcnt lgkmcnt(0)
    v_mfma_f32_16x16x32_bf16 v[64:67], v[160:163], v[28:31], 0
    v_mfma_f32_16x16x32_bf16 v[68:71], v[164:167], v[28:31], 0
    v_mfma_f32_16x16x32_bf16 v[72:75], v[168:171], v[28:31], 0
    v_mfma_f32_16x16x32_bf16 v[76:79], v[172:175], v[28:31], 0
    v_mfma_f32_16x16x32_bf16 v[80:83], v[176:179], v[28:31], 0
    v_mfma_f32_16x16x32_bf16 v[84:87], v[180:183], v[28:31], 0
    v_mfma_f32_16x16x32_bf16 v[88:91], v[184:187], v[28:31], 0
    v_mfma_f32_16x16x32_bf16 v[92:95], v[188:191], v[28:31], 0
    s_mov_b32 exec_lo, 0x00010001
    s_mov_b32 exec_hi, 0x00010001
    buffer_store_dwordx4 v[64:67], v9, s[40:43], s74 offen offset:0 sc1
    buffer_store_dwordx4 v[68:71], v9, s[40:43], s74 offen offset:64 sc1
    buffer_store_dwordx4 v[72:75], v9, s[40:43], s74 offen offset:128 sc1
    buffer_store_dwordx4 v[76:79], v9, s[40:43], s74 offen offset:192 sc1
    buffer_store_dwordx4 v[80:83], v9, s[40:43], s74 offen offset:256 sc1
    buffer_store_dwordx4 v[84:87], v9, s[40:43], s74 offen offset:320 sc1
    buffer_store_dwordx4 v[88:91], v9, s[40:43], s74 offen offset:384 sc1
    buffer_store_dwordx4 v[92:95], v9, s[40:43], s74 offen offset:448 sc1
    s_mov_b64 exec, -1
    s_branch L_fin
L_s4:
    s_cmp_eq_u32 s60, 0
    s_cbranch_scc0 L_fin
    v_lshrrev_b32 v8, 3, v1
    v_lshlrev_b32 v8, 11, v8
    v_and_b32 v9, 7, v1
    v_lshl_add_u32 v8, v9, 4, v8
    s_lshl_b32 s74, s73, 6
    v_lshl_add_u32 v7, v9, 3, s74
    s_lshl_b32 s74, s73, 7
    s_add_u32 s75, s74, 0x8000
    s_add_u32 s76, s74, 0xc000
    s_add_u32 s64, s74, 0x10000
    s_add_u32 s65, s74, 0x14000
    s_add_u32 s66, s74, 0x18000
    s_add_u32 s67, s74, 0x1c000
    s_add_u32 s68, s74, 0x20000
    s_add_u32 s69, s74, 0x24000
    s_add_u32 s70, s74, 0x28000
    s_mov_b32 s77, 0
    s_cmp_eq_u32 s73, 0
    s_cselect_b32 s71, 0x7000, s43
    s_cselect_b32 s71, s71, 0x30000000
    v_mov_b32 v11, s63
    s_mov_b32 s79, 65536
L_p4:
    buffer_load_dwordx4 v[16:19], v8, s[40:43], s75 offen sc1
    buffer_load_dwordx4 v[20:23], v8, s[40:43], s76 offen sc1
    s_waitcnt vmcnt(0)
    v_max3_u32 v10, v16, v17, v18
    v_max3_u32 v10, v10, v19, v20
    v_max3_u32 v10, v10, v21, v22
    v_max_u32 v10, v10, v23
    v_cmp_eq_u32 vcc, -1, v10
    s_cbranch_vccz L_p4_ok
    s_sub_u32 s79, s79, 1
    s_cmp_lg_u32 s79, 0
    s_cbranch_scc1 L_p4
L_p4_ok:
    v_pk_add_f32 v[16:17], v[16:17], v[20:21]
    v_pk_add_f32 v[18:19], v[18:19], v[22:23]
    s_nop 0
    v_add_f32_dpp v16, v16, v16 row_ror:8 row_mask:0xf bank_mask:0xf
    v_add_f32_dpp v17, v17, v17 row_ror:8 row_mask:0xf bank_mask:0xf
    v_add_f32_dpp v18, v18, v18 row_ror:8 row_mask:0xf bank_mask:0xf
    v_add_f32_dpp v19, v19, v19 row_ror:8 row_mask:0xf bank_mask:0xf
    v_mov_b32 v20, v16
    v_mov_b32 v21, v17
    v_mov_b32 v22, v18
    v_mov_b32 v23, v19
    v_permlane16_swap_b32 v20, v16
    v_permlane16_swap_b32 v21, v17
    v_permlane16_swap_b32 v22, v18
    v_permlane16_swap_b32 v23, v19
    v_add_f32 v16, v16, v20
    v_add_f32 v17, v17, v21
    v_add_f32 v18, v18, v22
    v_add_f32 v19, v19, v23
    v_mov_b32 v20, v16
    v_mov_b32 v21, v17
    v_mov_b32 v22, v18
    v_mov_b32 v23, v19
    v_permlane32_swap_b32 v20, v16
    v_permlane32_swap_b32 v21, v17
    v_permlane32_swap_b32 v22, v18
    v_permlane32_swap_b32 v23, v19
    v_add_f32 v16, v16, v20
    v_add_f32 v17, v17, v21
    v_add_f32 v18, v18, v22
    v_add_f32 v19, v19, v23
    v_cvt_pk_bf16_f32 v16, 0, v16
    v_cvt_pk_bf16_f32 v17, 0, v17
    v_cvt_pk_bf16_f32 v18, 0, v18
    v_cvt_pk_bf16_f32 v19, 0, v19
    v_lshlrev_b32 v24, 16, v40
    v_and_b32 v25, 0xffff0000, v40
    v_lshlrev_b32 v28, 16, v42
    v_and_b32 v29, 0xffff0000, v42
    v_lshlrev_b32 v26, 16, v41
    v_and_b32 v27, 0xffff0000, v41
    v_lshlrev_b32 v30, 16, v43
    v_and_b32 v31, 0xffff0000, v43
    v_pk_add_f32 v[16:17], v[16:17], v[24:25]
    v_pk_add_f32 v[18:19], v[18:19], v[26:27]
    v_cvt_pk_bf16_f32 v16, 0, v16
    v_cvt_pk_bf16_f32 v17, 0, v17
    v_cvt_pk_bf16_f32 v18, 0, v18
    v_cvt_pk_bf16_f32 v19, 0, v19
    v_mov_b32 v48, -1
    v_mov_b32 v49, -1
    v_mov_b32 v50, -1
    v_mov_b32 v51, -1
    v_mov_b32 v52, -1
    v_mov_b32 v53, -1
    v_mov_b32 v54, -1
    s_mov_b32 s79, 65536
L_p5:
    v_cmpx_eq_u32 vcc, -1, v48
    buffer_load_dwordx4 v[64:67], v8, s[40:43], s64 offen sc1
    s_mov_b64 exec, -1
    v_cmpx_eq_u32 vcc, -1, v49
    buffer_load_dwordx4 v[68:71], v8, s[40:43], s65 offen sc1
    s_mov_b64 exec, -1
    v_cmpx_eq_u32 vcc, -1, v50
    buffer_load_dwordx4 v[72:75], v8, s[40:43], s66 offen sc1
    s_mov_b64 exec, -1
    v_cmpx_eq_u32 vcc, -1, v51
    buffer_load_dwordx4 v[76:79], v8, s[40:43], s67 offen sc1
    s_mov_b64 exec, -1
    v_cmpx_eq_u32 vcc, -1, v52
    buffer_load_dwordx4 v[80:83], v8, s[40:43], s68 offen sc1
    s_mov_b64 exec, -1
    v_cmpx_eq_u32 vcc, -1, v53
    buffer_load_dwordx4 v[84:87], v8, s[40:43], s69 offen sc1
    s_mov_b64 exec, -1
    v_cmpx_eq_u32 vcc, -1, v54
    buffer_load_dwordx4 v[88:91], v8, s[40:43], s70 offen sc1
    s_mov_b64 exec, -1
    s_waitcnt vmcnt(0)
    v_max3_u32 v48, v64, v65, v66
    v_max3_u32 v49, v68, v69, v70
    v_max3_u32 v50, v72, v73, v74
    v_max3_u32 v51, v76, v77, v78
    v_max3_u32 v52, v80, v81, v82
    v_max3_u32 v53, v84, v85, v86
    v_max3_u32 v54, v88, v89, v90
    v_max_u32 v48, v48, v67
    v_max_u32 v49, v49, v71
    v_max_u32 v50, v50, v75
    v_max_u32 v51, v51, v79
    v_max_u32 v52, v52, v83
    v_max_u32 v53, v53, v87
    v_max_u32 v54, v54, v91
    v_max3_u32 v10, v48, v49, v50
    v_max3_u32 v10, v10, v51, v52
    v_max3_u32 v10, v10, v53, v54
    v_cmp_eq_u32 vcc, -1, v10
    s_cbranch_vccz L_p5_ok
    s_sub_u32 s79, s79, 1
    s_cmp_lg_u32 s79, 0
    s_cbranch_scc1 L_p5
L_p5_ok:
    v_pk_add_f32 v[64:65], v[64:65], v[80:81]
    v_pk_add_f32 v[66:67], v[66:67], v[82:83]
    v_pk_add_f32 v[68:69], v[68:69], v[84:85]
    v_pk_add_f32 v[70:71], v[70:71], v[86:87]
    v_pk_add_f32 v[72:73], v[72:73], v[88:89]
    v_pk_add_f32 v[74:75], v[74:75], v[90:91]
    v_pk_add_f32 v[64:65], v[64:65], v[72:73]
    v_pk_add_f32 v[66:67], v[66:67], v[74:75]
    v_pk_add_f32 v[68:69], v[68:69], v[76:77]
    v_pk_add_f32 v[70:71], v[70:71], v[78:79]
    v_pk_add_f32 v[64:65], v[64:65], v[68:69]
    v_pk_add_f32 v[66:67], v[66:67], v[70:71]
    s_nop 0
    v_add_f32_dpp v64, v64, v64 row_ror:8 row_mask:0xf bank_mask:0xf
    v_add_f32_dpp v65, v65, v65 row_ror:8 row_mask:0xf bank_mask:0xf
    v_add_f32_dpp v66, v66, v66 row_ror:8 row_mask:0xf bank_mask:0xf
    v_add_f32_dpp v67, v67, v67 row_ror:8 row_mask:0xf bank_mask:0xf
    v_mov_b32 v68, v64
    v_mov_b32 v69, v65
    v_mov_b32 v70, v66
    v_mov_b32 v71, v67
    v_permlane16_swap_b32 v68, v64
    v_permlane16_swap_b32 v69, v65
    v_permlane16_swap_b32 v70, v66
    v_permlane16_swap_b32 v71, v67
    v_add_f32 v64, v64, v68
    v_add_f32 v65, v65, v69
    v_add_f32 v66, v66, v70
    v_add_f32 v67, v67, v71
    v_mov_b32 v68, v64
    v_mov_b32 v69, v65
    v_mov_b32 v70, v66
    v_mov_b32 v71, v67
    v_permlane32_swap_b32 v68, v64
    v_permlane32_swap_b32 v69, v65
    v_permlane32_swap_b32 v70, v66
    v_permlane32_swap_b32 v71, v67
    v_add_f32 v64, v64, v68
    v_add_f32 v65, v65, v69
    v_add_f32 v66, v66, v70
    v_add_f32 v67, v67, v71
    v_cvt_pk_bf16_f32 v64, 0, v64
    v_cvt_pk_bf16_f32 v65, 0, v65
    v_cvt_pk_bf16_f32 v66, 0, v66
    v_cvt_pk_bf16_f32 v67, 0, v67
    v_pk_add_f32 v[64:65], v[64:65], v[28:29]
    v_pk_add_f32 v[66:67], v[66:67], v[30:31]
    v_cvt_pk_bf16_f32 v64, 0, v64
    v_cvt_pk_bf16_f32 v65, 0, v65
    v_cvt_pk_bf16_f32 v66, 0, v66
    v_cvt_pk_bf16_f32 v67, 0, v67
    v_pk_add_f32 v[64:65], v[64:65], v[16:17]
    v_pk_add_f32 v[66:67], v[66:67], v[18:19]
    v_cvt_pk_bf16_f32 v64, v64, v65
    v_cvt_pk_bf16_f32 v65, v66, v67
    s_mov_b64 exec, 0xff
    buffer_store_dwordx2 v[64:65], v7, s[44:47], s77 offen
    s_mov_b64 exec, 1
    buffer_store_dword v11, off, s[40:43], s71
    s_mov_b64 exec, -1
L_fin:
L_end:
    s_endpgm
.section .rodata,"a"
.p2align 6
.amdhsa_kernel sequential_preLN__gqa_block_cached__mixer_channel_mlp__decode_kernel
  .amdhsa_next_free_vgpr 256
  .amdhsa_next_free_sgpr 96
  .amdhsa_accum_offset 256
  .amdhsa_group_segment_fixed_size 0
  .amdhsa_kernarg_size 104
  .amdhsa_user_sgpr_count 2
  .amdhsa_user_sgpr_kernarg_segment_ptr 1
  .amdhsa_system_sgpr_workgroup_id_x 1
  .amdhsa_float_denorm_mode_32 3
.end_amdhsa_kernel
```
